```python
import torch

def _softmax(x, axis=-1):
    return torch.softmax(x, dim=axis)
def _gelu(x):
    return torch.nn.functional.gelu(x, approximate="tanh")
def _silu(x):
    return torch.nn.functional.silu(x)
def _sigmoid(x):
    return torch.sigmoid(x)
def _layernorm(x, axis=-1, eps=1e-5):
    m = x.mean(dim=axis, keepdim=True)
    v = x.var(dim=axis, keepdim=True, unbiased=False)
    return (x - m) / torch.sqrt(v + eps)
def _scatter_add(tgt, idx, src, axis=0):
    return tgt.clone().index_add_(axis, idx, src)
def _segment_sum(src, seg, n):
    out = torch.zeros((n,) + src.shape[1:], dtype=src.dtype)
    return out.index_add_(0, seg, src)
def _pad(x, pw):
    flat = tuple(v for pair in reversed(pw) for v in pair)
    return torch.nn.functional.pad(x, flat)

kernel_name = 'gated_mix__grouped_kv_mqa__geglu_ffn__prompt'

def setup_inputs():

    _w = (lambda a: (lambda t: t.to(torch.bfloat16) if t.is_floating_point() else t)(torch.as_tensor(a)))
    def _A_setup():
        B, S, D, H = 1, 2048, 512, 32
        Dh = D // H
        return {
            "x": _w((lambda *s: torch.randn(*s, dtype=torch.bfloat16) * 0.05)(B, S, D)),
            "wq": _w((lambda *s: torch.randn(*s, dtype=torch.bfloat16) * 0.8)(D, H * Dh)),
            "wk": _w((lambda *s: torch.randn(*s, dtype=torch.bfloat16) * 0.8)(D, Dh)),
            "wv": _w((lambda *s: torch.randn(*s, dtype=torch.bfloat16) * 0.05)(D, Dh)),
            "wo": _w((lambda *s: torch.randn(*s, dtype=torch.bfloat16) * 0.05)(H * Dh, D)),
        }
    _A_in = _A_setup()

    def _B_setup():
        B, S, D, F = 1, 2048, 512, 1792
        return {
            "x": _w((lambda *s: torch.randn(*s, dtype=torch.bfloat16) * 0.05)(B, S, D)),
            "w_gate": _w((lambda *s: torch.randn(*s, dtype=torch.bfloat16) * 0.05)(D, F)),
            "w_up": _w((lambda *s: torch.randn(*s, dtype=torch.bfloat16) * 0.05)(D, F)),
            "w_down": _w((lambda *s: torch.randn(*s, dtype=torch.bfloat16) * 0.05)(F, D)),
        }
    _B_in = _B_setup()

    return {
        "A_x": _A_in["x"],
        "A_wq": _A_in["wq"],
        "A_wk": _A_in["wk"],
        "A_wv": _A_in["wv"],
        "A_wo": _A_in["wo"],
        "B_x": _B_in["x"],
        "B_w_gate": _B_in["w_gate"],
        "B_w_up": _B_in["w_up"],
        "B_w_down": _B_in["w_down"],
        "gate_w": _w((lambda *s: torch.randn(*s, dtype=torch.bfloat16) * 0.05)(512) * 16.0),
    }

def reference(A_x, A_wq, A_wk, A_wv, A_wo, B_x, B_w_gate, B_w_up, B_w_down, gate_w):
    def _A_ref(x, wq, wk, wv, wo):
        B, S, D = x.shape
        H = 32
        Dh = D // H
        q = (lambda x, *d: x.permute(*d))((x @ wq).reshape(B, S, H, Dh), 0, 2, 1, 3)
        k = x @ wk
        v = x @ wv
        scores = torch.einsum("bhqd,bkd->bhqk", q, k) * (Dh ** -0.5)
        p = _softmax(scores, axis=-1)
        o = torch.einsum("bhqk,bkd->bhqd", p, v)
        return (lambda x, *d: x.permute(*d))(o, 0, 2, 1, 3).reshape(B, S, H * Dh) @ wo

    def _B_ref(x, w_gate, w_up, w_down):
        return (_gelu(x @ w_gate) * (x @ w_up)) @ w_down

    x = A_x
    g = _sigmoid((x * gate_w).sum(-1, keepdims=True))
    a = _A_ref(x, A_wq, A_wk, A_wv, A_wo)
    b = _B_ref(x, B_w_gate, B_w_up, B_w_down)
    return g * a + (1 - g) * b
```

```asm
; @launch grid=(256,1,1) block=(512,1,1) lds=163840
.amdgcn_target "amdgcn-amd-amdhsa--gfx950"
.text
.globl gated_mix__grouped_kv_mqa__geglu_ffn__prompt_kernel
.p2align 8
.type gated_mix__grouped_kv_mqa__geglu_ffn__prompt_kernel,@function
.set CODE_PF_MAX, L_codeend - L_nopf - 4
gated_mix__grouped_kv_mqa__geglu_ffn__prompt_kernel:
    s_load_dwordx2 s[4:5], s[0:1], 0
    s_load_dwordx2 s[8:9], s[0:1], 48
    s_load_dwordx2 s[12:13], s[0:1], 56
    s_load_dwordx2 s[16:17], s[0:1], 8
    v_lshrrev_b32 v2, 6, v0
    s_getpc_b64 s[62:63]
L_nopf:
    s_and_b32 s68, s2, -8
    v_add_lshl_u32 v4, v2, s68, 7
    v_mov_b32 v5, 0
    v_min_u32 v4, CODE_PF_MAX, v4
    v_lshl_add_u64 v[4:5], v[4:5], 0, s[62:63]
    global_load_dword v14, v[4:5], off
    s_load_dwordx8 s[32:39], s[0:1], 64
    v_readfirstlane_b32 s50, v2
    s_load_dwordx2 s[20:21], s[0:1], 96
    s_load_dwordx2 s[28:29], s[0:1], 32
    s_cmpk_ge_u32 s2, 256
    s_cbranch_scc1 L_end
    s_bfe_u32 s71, s2, 0x10002
    s_bfe_u32 s68, s2, 0x30003
    s_lshl3_add_u32 s53, s71, s68
    s_and_b32 s68, s2, 3
    s_lshr_b32 s69, s2, 6
    s_lshl2_add_u32 s81, s68, s69
    s_lshr_b32 s69, s81, 3
    s_sub_u32 s54, s81, s69
    s_lshl_b32 s57, s50, 10
    s_andn2_b32 s68, 7, s81
    s_cbranch_scc0 L_light
    s_add_u32 s68, s53, s81
    s_bfe_u32 s74, s68, 0x10000
    s_lshl2_add_u32 s74, s71, s74
    s_and_b32 s58, s57, 0xc00
    v_and_b32 v255, 0xff, v0
    s_cmp_ge_u32 s50, 4
    s_cbranch_scc1 L_setB
    s_mov_b32 s10, 0x1c0000
    s_mov_b32 s11, 0x20000
    s_mov_b64 s[14:15], s[10:11]
    v_lshrrev_b32 v2, 4, v255
    v_lshrrev_b32 v3, 5, v255
    v_bfi_b32 v3, 3, v2, v3
    v_lshlrev_b32 v3, 1, v3
    v_xor_b32 v3, v3, v255
    v_and_b32 v3, 15, v3
    s_lshl_b32 s68, s54, 8
    v_lshl_add_u32 v3, v3, 4, s68
    v_mul_u32_u24 v2, 3584, v2
    v_add_u32 v250, v2, v3
    s_waitcnt lgkmcnt(0)
    s_add_u32 m0, s58, 0x0
    s_mul_i32 s72, s74, 229376
    buffer_load_dwordx4 v250, s[8:11], s72 offen lds
    s_add_u32 m0, s58, 0xc000
    s_nop 0
    buffer_load_dwordx4 v250, s[12:15], s72 offen lds
    s_add_u32 m0, s58, 0x1000
    s_add_u32 s72, s72, 0xe000
    buffer_load_dwordx4 v250, s[8:11], s72 offen lds
    s_add_u32 m0, s58, 0xd000
    s_nop 0
    buffer_load_dwordx4 v250, s[12:15], s72 offen lds
    s_add_u32 m0, s58, 0x2000
    s_add_u32 s72, s72, 0xe000
    buffer_load_dwordx4 v250, s[8:11], s72 offen lds
    s_add_u32 m0, s58, 0xe000
    s_nop 0
    buffer_load_dwordx4 v250, s[12:15], s72 offen lds
    s_add_u32 m0, s58, 0x3000
    s_add_u32 s72, s72, 0xe000
    buffer_load_dwordx4 v250, s[8:11], s72 offen lds
    s_add_u32 m0, s58, 0xf000
    s_nop 0
    buffer_load_dwordx4 v250, s[12:15], s72 offen lds
    s_branch L_setA
L_setB:
    s_mov_b32 s6, 0x200000
    s_mov_b32 s7, 0x20000
    v_lshrrev_b32 v2, 4, v255
    v_xor_b32 v2, v2, v255
    v_and_b32 v2, 7, v2
    s_lshl_b32 s68, s53, 17
    v_lshl_add_u32 v2, v2, 4, s68
    v_lshrrev_b32 v3, 3, v255
    v_lshl_add_u32 v249, v3, 10, v2
    s_waitcnt lgkmcnt(0)
    s_add_u32 m0, s58, 0x18000
    s_lshl_b32 s72, s74, 7
    buffer_load_dwordx4 v249, s[4:7], s72 offen lds
    s_add_u32 m0, s58, 0x19000
    s_add_u32 s72, s72, 0x8000
    buffer_load_dwordx4 v249, s[4:7], s72 offen lds
    s_add_u32 m0, s58, 0x1a000
    s_add_u32 s72, s72, 0x8000
    buffer_load_dwordx4 v249, s[4:7], s72 offen lds
    s_add_u32 m0, s58, 0x1b000
    s_add_u32 s72, s72, 0x8000
    buffer_load_dwordx4 v249, s[4:7], s72 offen lds
    s_mov_b32 s18, 0x80000
    s_mov_b32 s19, 0x20000
    v_lshrrev_b32 v2, 4, v255
    v_and_b32 v2, 2, v2
    v_xor_b32 v2, v2, v255
    v_and_b32 v2, 3, v2
    s_lshl_b32 s68, s81, 6
    v_lshl_add_u32 v2, v2, 4, s68
    v_lshrrev_b32 v3, 2, v255
    v_lshl_add_u32 v251, v3, 10, v2
    s_add_u32 m0, s58, 0x24000
    s_lshl_b32 s72, s74, 16
    buffer_load_dwordx4 v251, s[16:19], s72 offen lds
    s_add_u32 s68, s53, s81
    s_mov_b32 s75, 0x76543210
    s_mov_b32 s69, 0x76543210
    s_bitcmp1_b32 s68, 0
    s_cselect_b32 s75, 0x67452301, s75
    s_cselect_b32 s69, 0x67452301, s69
    s_bitcmp1_b32 s68, 1
    s_cselect_b32 s75, s69, s75
    s_bitcmp1_b32 s53, 3
    s_cselect_b32 s69, 0x44444444, 0
    s_xor_b32 s75, s75, s69
    s_mov_b64 s[64:65], s[20:21]
    s_mov_b64 s[24:25], s[32:33]
    s_mov_b64 s[32:33], s[36:37]
    s_mov_b64 s[36:37], s[38:39]
    v_and_b32 v0, 63, v0
    v_lshlrev_b32 v1, 4, v0
    s_and_b32 s68, s2, 7
    s_xor_b32 s68, s68, 4
    s_bfe_u32 s69, s2, 0x20003
    s_lshl2_add_u32 s55, s68, s69
    s_lshr_b32 s56, s2, 5
    s_mov_b32 s10, 0x1c0000
    s_mov_b32 s11, 0x20000
    s_mov_b64 s[14:15], s[10:11]
    s_barrier
    s_add_u32 m0, s58, 0x25000
    s_bfe_u32 s74, s75, 0x30004
    s_lshl_b32 s72, s74, 16
    buffer_load_dwordx4 v251, s[16:19], s72 offen lds
    s_lshr_b32 s51, s50, 2
    s_and_b32 s52, s50, 3
    v_and_b32 v2, 15, v0
    v_lshrrev_b32 v3, 4, v0
    v_bfe_u32 v4, v0, 1, 3
    v_xor_b32 v4, v4, v3
    v_lshlrev_b32 v4, 4, v4
    v_lshl_add_u32 v240, v2, 7, v4
    v_bfe_u32 v2, v0, 2, 2
    v_and_b32 v4, 3, v0
    v_lshl_add_u32 v248, v3, 3, v2
    v_lshlrev_b32 v248, 6, v248
    v_xor_b32 v5, s51, v3
    s_add_u32 m0, s58, 0x1c000
    s_lshl_b32 s72, s74, 7
    buffer_load_dwordx4 v249, s[4:7], s72 offen lds
    v_and_b32 v5, 1, v5
    v_lshl_add_u32 v248, v5, 5, v248
    v_lshl_add_u32 v248, v4, 3, v248
    v_lshl_add_u32 v244, v3, 3, v2
    v_lshlrev_b32 v244, 8, v244
    v_lshl_add_u32 v244, v4, 3, v244
    v_and_b32 v5, 1, v3
    v_lshl_add_u32 v2, v5, 2, v2
    s_lshl_b32 s68, s51, 2
    s_and_b32 s69, s52, 1
    s_lshl_b32 s69, s69, 1
    s_add_u32 s68, s68, s69
    v_xor_b32 v2, s68, v2
    s_add_u32 m0, s58, 0x1d000
    s_add_u32 s72, s72, 0x8000
    buffer_load_dwordx4 v249, s[4:7], s72 offen lds
    v_lshl_add_u32 v244, v2, 5, v244
    v_xor_b32 v245, 32, v244
    v_add_u32 v246, 0xc000, v244
    v_add_u32 v247, 0xc000, v245
    s_lshl_b32 s68, s52, 12
    s_add_u32 s68, s68, 0x18000
    v_add_u32 v240, s68, v240
    v_xor_b32 v241, 0x1000, v240
    v_xor_b32 v242, 64, v240
    v_xor_b32 v243, 64, v241
    v_add_u32 v248, 0x24000, v248
    s_mov_b32 s22, 0x1000000
    s_mov_b32 s23, 0x20000
    s_add_u32 m0, s58, 0x1e000
    s_add_u32 s72, s72, 0x8000
    buffer_load_dwordx4 v249, s[4:7], s72 offen lds
    s_mov_b32 s66, 0x20000
    s_mov_b32 s67, 0x20000
    s_mov_b32 s38, 0x100
    s_mov_b32 s39, 0x20000
    s_mov_b32 s26, 0x1c0000
    s_mov_b32 s27, 0x20000
    s_mov_b32 s30, 0x80000
    s_mov_b32 s31, 0x20000
    s_mov_b32 s34, 0x200000
    s_mov_b32 s35, 0x20000
    v_mov_b32 v15, 0
    v_mov_b32 v10, 0
    v_mov_b32 v13, 0
    s_add_u32 m0, s58, 0x1f000
    s_add_u32 s72, s72, 0x8000
    buffer_load_dwordx4 v249, s[4:7], s72 offen lds
    v_mov_b32 v254, 0
    v_mov_b32 v12, 0
    v_lshrrev_b32 v2, 4, v255
    v_lshrrev_b32 v3, 5, v255
    v_bfi_b32 v3, 3, v2, v3
    v_lshlrev_b32 v3, 1, v3
    v_xor_b32 v3, v3, v255
    v_and_b32 v3, 15, v3
    s_lshl_b32 s68, s54, 8
    v_lshl_add_u32 v3, v3, 4, s68
    v_mul_u32_u24 v2, 3584, v2
    v_add_u32 v250, v2, v3
    s_and_b32 s68, s53, 7
    v_lshl_add_u32 v2, v0, 3, s68
    v_mul_u32_u24 v3, 3584, v2
    s_and_b32 s69, s50, 1
    s_lshl1_add_u32 s68, s54, s69
    s_lshl_b32 s68, s68, 7
    s_bitcmp1_b32 s53, 3
    s_cselect_b32 exec_lo, 0, 0xffff0000
    s_cselect_b32 exec_hi, 0xffff0000, 0
    s_cmp_ge_u32 s50, 6
    s_cbranch_scc1 L_tlbu
    buffer_load_dword v14, v3, s[8:11], s68 offen
    s_branch L_tlbe
L_tlbu:
    buffer_load_dword v14, v3, s[12:15], s68 offen
L_tlbe:
    s_mov_b64 exec, -1
    s_mov_b64 vcc, 0
    s_setprio 1
    s_waitcnt vmcnt(6) lgkmcnt(0)
    s_branch L_k0
L_setA:
    s_add_u32 s68, s53, s81
    s_mov_b32 s75, 0x76543210
    s_mov_b32 s69, 0x76543210
    s_bitcmp1_b32 s68, 0
    s_cselect_b32 s75, 0x67452301, s75
    s_cselect_b32 s69, 0x67452301, s69
    s_bitcmp1_b32 s68, 1
    s_cselect_b32 s75, s69, s75
    s_bitcmp1_b32 s53, 3
    s_cselect_b32 s69, 0x44444444, 0
    s_xor_b32 s75, s75, s69
    s_mov_b64 s[64:65], s[20:21]
    s_mov_b64 s[24:25], s[32:33]
    s_mov_b64 s[32:33], s[36:37]
    s_mov_b64 s[36:37], s[38:39]
    v_and_b32 v0, 63, v0
    v_lshlrev_b32 v1, 4, v0
    s_and_b32 s68, s2, 7
    s_xor_b32 s68, s68, 4
    s_bfe_u32 s69, s2, 0x20003
    s_lshl2_add_u32 s55, s68, s69
    s_lshr_b32 s56, s2, 5
    s_mov_b32 s6, 0x200000
    s_mov_b32 s7, 0x20000
    s_mov_b32 s18, 0x80000
    s_mov_b32 s19, 0x20000
    s_barrier
    s_add_u32 m0, s58, 0x4000
    s_bfe_u32 s74, s75, 0x30004
    s_mul_i32 s72, s74, 229376
    buffer_load_dwordx4 v250, s[8:11], s72 offen lds
    s_lshr_b32 s51, s50, 2
    s_and_b32 s52, s50, 3
    v_and_b32 v2, 15, v0
    v_lshrrev_b32 v3, 4, v0
    v_bfe_u32 v4, v0, 1, 3
    v_xor_b32 v4, v4, v3
    v_lshlrev_b32 v4, 4, v4
    v_lshl_add_u32 v240, v2, 7, v4
    v_bfe_u32 v2, v0, 2, 2
    s_add_u32 m0, s58, 0x10000
    s_nop 0
    buffer_load_dwordx4 v250, s[12:15], s72 offen lds
    v_and_b32 v4, 3, v0
    v_lshl_add_u32 v248, v3, 3, v2
    v_lshlrev_b32 v248, 6, v248
    v_xor_b32 v5, s51, v3
    v_and_b32 v5, 1, v5
    v_lshl_add_u32 v248, v5, 5, v248
    v_lshl_add_u32 v248, v4, 3, v248
    v_lshl_add_u32 v244, v3, 3, v2
    v_lshlrev_b32 v244, 8, v244
    s_add_u32 m0, s58, 0x5000
    s_add_u32 s72, s72, 0xe000
    buffer_load_dwordx4 v250, s[8:11], s72 offen lds
    v_lshl_add_u32 v244, v4, 3, v244
    v_and_b32 v5, 1, v3
    v_lshl_add_u32 v2, v5, 2, v2
    s_lshl_b32 s68, s51, 2
    s_and_b32 s69, s52, 1
    s_lshl_b32 s69, s69, 1
    s_add_u32 s68, s68, s69
    v_xor_b32 v2, s68, v2
    v_lshl_add_u32 v244, v2, 5, v244
    s_add_u32 m0, s58, 0x11000
    s_nop 0
    buffer_load_dwordx4 v250, s[12:15], s72 offen lds
    v_xor_b32 v245, 32, v244
    v_add_u32 v246, 0xc000, v244
    v_add_u32 v247, 0xc000, v245
    s_lshl_b32 s68, s52, 12
    s_add_u32 s68, s68, 0x18000
    v_add_u32 v240, s68, v240
    v_xor_b32 v241, 0x1000, v240
    v_xor_b32 v242, 64, v240
    v_xor_b32 v243, 64, v241
    s_add_u32 m0, s58, 0x6000
    s_add_u32 s72, s72, 0xe000
    buffer_load_dwordx4 v250, s[8:11], s72 offen lds
    v_add_u32 v248, 0x24000, v248
    s_mov_b32 s22, 0x1000000
    s_mov_b32 s23, 0x20000
    s_mov_b32 s66, 0x20000
    s_mov_b32 s67, 0x20000
    s_mov_b32 s38, 0x100
    s_mov_b32 s39, 0x20000
    s_mov_b32 s26, 0x1c0000
    s_mov_b32 s27, 0x20000
    s_add_u32 m0, s58, 0x12000
    s_nop 0
    buffer_load_dwordx4 v250, s[12:15], s72 offen lds
    s_mov_b32 s30, 0x80000
    s_mov_b32 s31, 0x20000
    s_mov_b32 s34, 0x200000
    s_mov_b32 s35, 0x20000
    v_mov_b32 v15, 0
    v_mov_b32 v10, 0
    v_mov_b32 v13, 0
    v_mov_b32 v254, 0
    v_mov_b32 v12, 0
    s_add_u32 m0, s58, 0x7000
    s_add_u32 s72, s72, 0xe000
    buffer_load_dwordx4 v250, s[8:11], s72 offen lds
    v_lshrrev_b32 v2, 4, v255
    v_and_b32 v2, 2, v2
    v_xor_b32 v2, v2, v255
    v_and_b32 v2, 3, v2
    s_lshl_b32 s68, s81, 6
    v_lshl_add_u32 v2, v2, 4, s68
    v_lshrrev_b32 v3, 2, v255
    v_lshl_add_u32 v251, v3, 10, v2
    v_lshrrev_b32 v2, 4, v255
    s_add_u32 m0, s58, 0x13000
    s_nop 0
    buffer_load_dwordx4 v250, s[12:15], s72 offen lds
    v_xor_b32 v2, v2, v255
    v_and_b32 v2, 7, v2
    s_lshl_b32 s68, s53, 17
    v_lshl_add_u32 v2, v2, 4, s68
    v_lshrrev_b32 v3, 3, v255
    v_lshl_add_u32 v249, v3, 10, v2
    s_cmp_lg_u32 s50, 0
    s_cbranch_scc1 L_tlbx
    s_and_b32 s68, s53, 7
    v_lshl_add_u32 v2, v0, 3, s68
    v_lshlrev_b32 v3, 10, v2
    s_lshl_b32 s68, s81, 6
    s_bitcmp1_b32 s53, 3
    s_cselect_b32 exec_lo, 0, 0xffff0000
    s_cselect_b32 exec_hi, 0xffff0000, 0
    buffer_load_dword v14, v3, s[16:19], s68 offen
    s_mov_b64 exec, -1
L_tlbx:
    s_mov_b64 vcc, -1
    s_waitcnt vmcnt(8) lgkmcnt(0)
L_k0:
    s_barrier
.p2align 3
    ds_read_b64_tr_b16 v[184:185], v244 offset:0
    ds_read_b64_tr_b16 v[186:187], v244 offset:1024
    ds_read_b128 v[168:171], v240 offset:0
    ds_read_b128 v[172:175], v240 offset:2048
    ds_read_b128 v[176:179], v241 offset:0
    ds_read_b128 v[180:183], v241 offset:2048
    ds_read_b64_tr_b16 v[192:193], v246 offset:0
    ds_read_b64_tr_b16 v[194:195], v246 offset:1024
    ds_read_b64_tr_b16 v[188:189], v245 offset:0
    ds_read_b64_tr_b16 v[190:191], v245 offset:1024
    ds_read_b64_tr_b16 v[196:197], v247 offset:0
    ds_read_b64_tr_b16 v[198:199], v247 offset:1024
    ds_read_b64_tr_b16 v[200:201], v248 offset:0
    ds_read_b64_tr_b16 v[202:203], v248 offset:256
    s_waitcnt lgkmcnt(6)
    v_mfma_f32_16x16x32_bf16 v[104:107], v[184:187], v[168:171], 0
    ds_read_b64_tr_b16 v[220:221], v244 offset:8192
    v_mfma_f32_16x16x32_bf16 v[120:123], v[184:187], v[172:175], 0
    ds_read_b64_tr_b16 v[222:223], v244 offset:9216
    v_mfma_f32_16x16x32_bf16 v[136:139], v[184:187], v[176:179], 0
    ds_read_b128 v[204:207], v242 offset:0
    v_mfma_f32_16x16x32_bf16 v[152:155], v[184:187], v[180:183], 0
    ds_read_b128 v[208:211], v242 offset:2048
    v_mfma_f32_16x16x32_bf16 v[160:163], v[192:195], v[180:183], 0
    ds_read_b128 v[212:215], v243 offset:0
    v_mfma_f32_16x16x32_bf16 v[144:147], v[192:195], v[176:179], 0
    ds_read_b128 v[216:219], v243 offset:2048
    v_mfma_f32_16x16x32_bf16 v[128:131], v[192:195], v[172:175], 0
    ds_read_b64_tr_b16 v[228:229], v246 offset:8192
    v_mfma_f32_16x16x32_bf16 v[112:115], v[192:195], v[168:171], 0
    s_waitcnt lgkmcnt(7)
    v_mfma_f32_16x16x32_bf16 v[108:111], v[188:191], v[168:171], 0
    ds_read_b64_tr_b16 v[230:231], v246 offset:9216
    v_mfma_f32_16x16x32_bf16 v[124:127], v[188:191], v[172:175], 0
    ds_read_b64_tr_b16 v[224:225], v245 offset:8192
    v_mfma_f32_16x16x32_bf16 v[140:143], v[188:191], v[176:179], 0
    ds_read_b64_tr_b16 v[226:227], v245 offset:9216
    v_mfma_f32_16x16x32_bf16 v[156:159], v[188:191], v[180:183], 0
    ds_read_b64_tr_b16 v[232:233], v247 offset:8192
    v_mfma_f32_16x16x32_bf16 v[164:167], v[196:199], v[180:183], 0
    ds_read_b64_tr_b16 v[234:235], v247 offset:9216
    v_mfma_f32_16x16x32_bf16 v[148:151], v[196:199], v[176:179], 0
    ds_read_b64_tr_b16 v[236:237], v248 offset:2048
    v_mfma_f32_16x16x32_bf16 v[132:135], v[196:199], v[172:175], 0
    ds_read_b64_tr_b16 v[238:239], v248 offset:2304
    v_mfma_f32_16x16x32_bf16 v[116:119], v[196:199], v[168:171], 0
    v_mfma_f32_16x16x32_bf16 v[32:35], v[200:203], v[168:171], 0
    v_mfma_f32_16x16x32_bf16 v[36:39], v[200:203], v[172:175], 0
    s_waitcnt lgkmcnt(8)
    v_mfma_f32_16x16x32_bf16 v[104:107], v[220:223], v[204:207], v[104:107]
    v_mfma_f32_16x16x32_bf16 v[120:123], v[220:223], v[208:211], v[120:123]
    v_mfma_f32_16x16x32_bf16 v[136:139], v[220:223], v[212:215], v[136:139]
    s_cbranch_vccz L_e2
    s_waitcnt vmcnt(0) lgkmcnt(0)
L_e2_r:
    s_barrier
    s_cbranch_vccnz L_d3
L_d3_r:
    v_mfma_f32_16x16x32_bf16 v[152:155], v[220:223], v[216:219], v[152:155]
    ds_read_b64_tr_b16 v[184:185], v244 offset:16384
    v_mfma_f32_16x16x32_bf16 v[160:163], v[228:231], v[216:219], v[160:163]
    ds_read_b64_tr_b16 v[186:187], v244 offset:17408
    v_mfma_f32_16x16x32_bf16 v[144:147], v[228:231], v[212:215], v[144:147]
    ds_read_b128 v[168:171], v240 offset:16384
    v_mfma_f32_16x16x32_bf16 v[128:131], v[228:231], v[208:211], v[128:131]
    ds_read_b128 v[172:175], v240 offset:18432
    v_mfma_f32_16x16x32_bf16 v[112:115], v[228:231], v[204:207], v[112:115]
    ds_read_b128 v[176:179], v241 offset:16384
    v_mfma_f32_16x16x32_bf16 v[108:111], v[224:227], v[204:207], v[108:111]
    ds_read_b128 v[180:183], v241 offset:18432
    v_mfma_f32_16x16x32_bf16 v[124:127], v[224:227], v[208:211], v[124:127]
    ds_read_b64_tr_b16 v[192:193], v246 offset:16384
    v_mfma_f32_16x16x32_bf16 v[140:143], v[224:227], v[212:215], v[140:143]
    ds_read_b64_tr_b16 v[194:195], v246 offset:17408
    v_mfma_f32_16x16x32_bf16 v[156:159], v[224:227], v[216:219], v[156:159]
    ds_read_b64_tr_b16 v[188:189], v245 offset:16384
    v_mfma_f32_16x16x32_bf16 v[164:167], v[232:235], v[216:219], v[164:167]
    ds_read_b64_tr_b16 v[190:191], v245 offset:17408
    v_mfma_f32_16x16x32_bf16 v[148:151], v[232:235], v[212:215], v[148:151]
    ds_read_b64_tr_b16 v[196:197], v247 offset:16384
    v_mfma_f32_16x16x32_bf16 v[132:135], v[232:235], v[208:211], v[132:135]
    ds_read_b64_tr_b16 v[198:199], v247 offset:17408
    v_mfma_f32_16x16x32_bf16 v[116:119], v[232:235], v[204:207], v[116:119]
    ds_read_b64_tr_b16 v[200:201], v248 offset:4096
    v_mfma_f32_16x16x32_bf16 v[32:35], v[236:239], v[204:207], v[32:35]
    ds_read_b64_tr_b16 v[202:203], v248 offset:4352
    v_mfma_f32_16x16x32_bf16 v[36:39], v[236:239], v[208:211], v[36:39]
    s_waitcnt lgkmcnt(6)
    v_mfma_f32_16x16x32_bf16 v[104:107], v[184:187], v[168:171], v[104:107]
    ds_read_b64_tr_b16 v[220:221], v244 offset:24576
    v_mfma_f32_16x16x32_bf16 v[120:123], v[184:187], v[172:175], v[120:123]
    ds_read_b64_tr_b16 v[222:223], v244 offset:25600
    v_mfma_f32_16x16x32_bf16 v[136:139], v[184:187], v[176:179], v[136:139]
    ds_read_b128 v[204:207], v242 offset:16384
    v_mfma_f32_16x16x32_bf16 v[152:155], v[184:187], v[180:183], v[152:155]
    ds_read_b128 v[208:211], v242 offset:18432
    v_mfma_f32_16x16x32_bf16 v[160:163], v[192:195], v[180:183], v[160:163]
    ds_read_b128 v[212:215], v243 offset:16384
    v_mfma_f32_16x16x32_bf16 v[144:147], v[192:195], v[176:179], v[144:147]
    ds_read_b128 v[216:219], v243 offset:18432
    v_mfma_f32_16x16x32_bf16 v[128:131], v[192:195], v[172:175], v[128:131]
    ds_read_b64_tr_b16 v[228:229], v246 offset:24576
    v_mfma_f32_16x16x32_bf16 v[112:115], v[192:195], v[168:171], v[112:115]
    s_waitcnt lgkmcnt(7)
    v_mfma_f32_16x16x32_bf16 v[108:111], v[188:191], v[168:171], v[108:111]
    ds_read_b64_tr_b16 v[230:231], v246 offset:25600
    v_mfma_f32_16x16x32_bf16 v[124:127], v[188:191], v[172:175], v[124:127]
    ds_read_b64_tr_b16 v[224:225], v245 offset:24576
    v_mfma_f32_16x16x32_bf16 v[140:143], v[188:191], v[176:179], v[140:143]
    ds_read_b64_tr_b16 v[226:227], v245 offset:25600
    v_mfma_f32_16x16x32_bf16 v[156:159], v[188:191], v[180:183], v[156:159]
    ds_read_b64_tr_b16 v[232:233], v247 offset:24576
    v_mfma_f32_16x16x32_bf16 v[164:167], v[196:199], v[180:183], v[164:167]
    ds_read_b64_tr_b16 v[234:235], v247 offset:25600
    v_mfma_f32_16x16x32_bf16 v[148:151], v[196:199], v[176:179], v[148:151]
    ds_read_b64_tr_b16 v[236:237], v248 offset:6144
    v_mfma_f32_16x16x32_bf16 v[132:135], v[196:199], v[172:175], v[132:135]
    ds_read_b64_tr_b16 v[238:239], v248 offset:6400
    v_mfma_f32_16x16x32_bf16 v[116:119], v[196:199], v[168:171], v[116:119]
    v_mfma_f32_16x16x32_bf16 v[32:35], v[200:203], v[168:171], v[32:35]
    v_mfma_f32_16x16x32_bf16 v[36:39], v[200:203], v[172:175], v[36:39]
    s_waitcnt lgkmcnt(8)
    v_mfma_f32_16x16x32_bf16 v[104:107], v[220:223], v[204:207], v[104:107]
    v_mfma_f32_16x16x32_bf16 v[120:123], v[220:223], v[208:211], v[120:123]
    v_mfma_f32_16x16x32_bf16 v[136:139], v[220:223], v[212:215], v[136:139]
    s_cbranch_vccz L_e3
    s_waitcnt vmcnt(0) lgkmcnt(0)
L_e3_r:
    s_barrier
    s_cbranch_vccnz L_d4
L_d4_r:
    v_mfma_f32_16x16x32_bf16 v[152:155], v[220:223], v[216:219], v[152:155]
    ds_read_b64_tr_b16 v[184:185], v244 offset:32768
    v_mfma_f32_16x16x32_bf16 v[160:163], v[228:231], v[216:219], v[160:163]
    ds_read_b64_tr_b16 v[186:187], v244 offset:33792
    v_mfma_f32_16x16x32_bf16 v[144:147], v[228:231], v[212:215], v[144:147]
    ds_read_b128 v[168:171], v240 offset:32768
    v_mfma_f32_16x16x32_bf16 v[128:131], v[228:231], v[208:211], v[128:131]
    ds_read_b128 v[172:175], v240 offset:34816
    v_mfma_f32_16x16x32_bf16 v[112:115], v[228:231], v[204:207], v[112:115]
    ds_read_b128 v[176:179], v241 offset:32768
    v_mfma_f32_16x16x32_bf16 v[108:111], v[224:227], v[204:207], v[108:111]
    ds_read_b128 v[180:183], v241 offset:34816
    v_mfma_f32_16x16x32_bf16 v[124:127], v[224:227], v[208:211], v[124:127]
    ds_read_b64_tr_b16 v[192:193], v246 offset:32768
    v_mfma_f32_16x16x32_bf16 v[140:143], v[224:227], v[212:215], v[140:143]
    ds_read_b64_tr_b16 v[194:195], v246 offset:33792
    v_mfma_f32_16x16x32_bf16 v[156:159], v[224:227], v[216:219], v[156:159]
    ds_read_b64_tr_b16 v[188:189], v245 offset:32768
    v_mfma_f32_16x16x32_bf16 v[164:167], v[232:235], v[216:219], v[164:167]
    ds_read_b64_tr_b16 v[190:191], v245 offset:33792
    v_mfma_f32_16x16x32_bf16 v[148:151], v[232:235], v[212:215], v[148:151]
    ds_read_b64_tr_b16 v[196:197], v247 offset:32768
    v_mfma_f32_16x16x32_bf16 v[132:135], v[232:235], v[208:211], v[132:135]
    ds_read_b64_tr_b16 v[198:199], v247 offset:33792
    v_mfma_f32_16x16x32_bf16 v[116:119], v[232:235], v[204:207], v[116:119]
    ds_read_b64_tr_b16 v[200:201], v248 offset:8192
    v_mfma_f32_16x16x32_bf16 v[32:35], v[236:239], v[204:207], v[32:35]
    ds_read_b64_tr_b16 v[202:203], v248 offset:8448
    v_mfma_f32_16x16x32_bf16 v[36:39], v[236:239], v[208:211], v[36:39]
    s_waitcnt lgkmcnt(6)
    v_mfma_f32_16x16x32_bf16 v[104:107], v[184:187], v[168:171], v[104:107]
    ds_read_b64_tr_b16 v[220:221], v244 offset:40960
    v_mfma_f32_16x16x32_bf16 v[120:123], v[184:187], v[172:175], v[120:123]
    ds_read_b64_tr_b16 v[222:223], v244 offset:41984
    v_mfma_f32_16x16x32_bf16 v[136:139], v[184:187], v[176:179], v[136:139]
    ds_read_b128 v[204:207], v242 offset:32768
    v_mfma_f32_16x16x32_bf16 v[152:155], v[184:187], v[180:183], v[152:155]
    ds_read_b128 v[208:211], v242 offset:34816
    v_mfma_f32_16x16x32_bf16 v[160:163], v[192:195], v[180:183], v[160:163]
    ds_read_b128 v[212:215], v243 offset:32768
    v_mfma_f32_16x16x32_bf16 v[144:147], v[192:195], v[176:179], v[144:147]
    ds_read_b128 v[216:219], v243 offset:34816
    v_mfma_f32_16x16x32_bf16 v[128:131], v[192:195], v[172:175], v[128:131]
    ds_read_b64_tr_b16 v[228:229], v246 offset:40960
    v_mfma_f32_16x16x32_bf16 v[112:115], v[192:195], v[168:171], v[112:115]
    s_waitcnt lgkmcnt(7)
    v_mfma_f32_16x16x32_bf16 v[108:111], v[188:191], v[168:171], v[108:111]
    ds_read_b64_tr_b16 v[230:231], v246 offset:41984
    v_mfma_f32_16x16x32_bf16 v[124:127], v[188:191], v[172:175], v[124:127]
    ds_read_b64_tr_b16 v[224:225], v245 offset:40960
    v_mfma_f32_16x16x32_bf16 v[140:143], v[188:191], v[176:179], v[140:143]
    ds_read_b64_tr_b16 v[226:227], v245 offset:41984
    v_mfma_f32_16x16x32_bf16 v[156:159], v[188:191], v[180:183], v[156:159]
    ds_read_b64_tr_b16 v[232:233], v247 offset:40960
    v_mfma_f32_16x16x32_bf16 v[164:167], v[196:199], v[180:183], v[164:167]
    ds_read_b64_tr_b16 v[234:235], v247 offset:41984
    v_mfma_f32_16x16x32_bf16 v[148:151], v[196:199], v[176:179], v[148:151]
    ds_read_b64_tr_b16 v[236:237], v248 offset:10240
    v_mfma_f32_16x16x32_bf16 v[132:135], v[196:199], v[172:175], v[132:135]
    ds_read_b64_tr_b16 v[238:239], v248 offset:10496
    v_mfma_f32_16x16x32_bf16 v[116:119], v[196:199], v[168:171], v[116:119]
    v_mfma_f32_16x16x32_bf16 v[32:35], v[200:203], v[168:171], v[32:35]
    v_mfma_f32_16x16x32_bf16 v[36:39], v[200:203], v[172:175], v[36:39]
    s_waitcnt lgkmcnt(8)
    v_mfma_f32_16x16x32_bf16 v[104:107], v[220:223], v[204:207], v[104:107]
    v_mfma_f32_16x16x32_bf16 v[120:123], v[220:223], v[208:211], v[120:123]
    v_mfma_f32_16x16x32_bf16 v[136:139], v[220:223], v[212:215], v[136:139]
    s_cbranch_vccz L_e4
    s_waitcnt vmcnt(1) lgkmcnt(0)
L_e4_r:
    s_barrier
    s_cbranch_vccnz L_d5
L_d5_r:
    v_mfma_f32_16x16x32_bf16 v[152:155], v[220:223], v[216:219], v[152:155]
    ds_read_b64_tr_b16 v[184:185], v244 offset:0
    v_mfma_f32_16x16x32_bf16 v[160:163], v[228:231], v[216:219], v[160:163]
    ds_read_b64_tr_b16 v[186:187], v244 offset:1024
    v_mfma_f32_16x16x32_bf16 v[144:147], v[228:231], v[212:215], v[144:147]
    ds_read_b128 v[168:171], v240 offset:0
    v_mfma_f32_16x16x32_bf16 v[128:131], v[228:231], v[208:211], v[128:131]
    ds_read_b128 v[172:175], v240 offset:2048
    v_mfma_f32_16x16x32_bf16 v[112:115], v[228:231], v[204:207], v[112:115]
    ds_read_b128 v[176:179], v241 offset:0
    v_mfma_f32_16x16x32_bf16 v[108:111], v[224:227], v[204:207], v[108:111]
    ds_read_b128 v[180:183], v241 offset:2048
    v_mfma_f32_16x16x32_bf16 v[124:127], v[224:227], v[208:211], v[124:127]
    ds_read_b64_tr_b16 v[192:193], v246 offset:0
    v_mfma_f32_16x16x32_bf16 v[140:143], v[224:227], v[212:215], v[140:143]
    ds_read_b64_tr_b16 v[194:195], v246 offset:1024
    v_mfma_f32_16x16x32_bf16 v[156:159], v[224:227], v[216:219], v[156:159]
    ds_read_b64_tr_b16 v[188:189], v245 offset:0
    v_mfma_f32_16x16x32_bf16 v[164:167], v[232:235], v[216:219], v[164:167]
    ds_read_b64_tr_b16 v[190:191], v245 offset:1024
    v_mfma_f32_16x16x32_bf16 v[148:151], v[232:235], v[212:215], v[148:151]
    ds_read_b64_tr_b16 v[196:197], v247 offset:0
    v_mfma_f32_16x16x32_bf16 v[132:135], v[232:235], v[208:211], v[132:135]
    ds_read_b64_tr_b16 v[198:199], v247 offset:1024
    v_mfma_f32_16x16x32_bf16 v[116:119], v[232:235], v[204:207], v[116:119]
    ds_read_b64_tr_b16 v[200:201], v248 offset:0
    v_mfma_f32_16x16x32_bf16 v[32:35], v[236:239], v[204:207], v[32:35]
    ds_read_b64_tr_b16 v[202:203], v248 offset:256
    v_mfma_f32_16x16x32_bf16 v[36:39], v[236:239], v[208:211], v[36:39]
    s_waitcnt lgkmcnt(6)
    v_mfma_f32_16x16x32_bf16 v[104:107], v[184:187], v[168:171], v[104:107]
    ds_read_b64_tr_b16 v[220:221], v244 offset:8192
    v_mfma_f32_16x16x32_bf16 v[120:123], v[184:187], v[172:175], v[120:123]
    ds_read_b64_tr_b16 v[222:223], v244 offset:9216
    v_mfma_f32_16x16x32_bf16 v[136:139], v[184:187], v[176:179], v[136:139]
    ds_read_b128 v[204:207], v242 offset:0
    v_mfma_f32_16x16x32_bf16 v[152:155], v[184:187], v[180:183], v[152:155]
    ds_read_b128 v[208:211], v242 offset:2048
    v_mfma_f32_16x16x32_bf16 v[160:163], v[192:195], v[180:183], v[160:163]
    ds_read_b128 v[212:215], v243 offset:0
    v_mfma_f32_16x16x32_bf16 v[144:147], v[192:195], v[176:179], v[144:147]
    ds_read_b128 v[216:219], v243 offset:2048
    v_mfma_f32_16x16x32_bf16 v[128:131], v[192:195], v[172:175], v[128:131]
    ds_read_b64_tr_b16 v[228:229], v246 offset:8192
    v_mfma_f32_16x16x32_bf16 v[112:115], v[192:195], v[168:171], v[112:115]
    s_waitcnt lgkmcnt(7)
    v_mfma_f32_16x16x32_bf16 v[108:111], v[188:191], v[168:171], v[108:111]
    ds_read_b64_tr_b16 v[230:231], v246 offset:9216
    v_mfma_f32_16x16x32_bf16 v[124:127], v[188:191], v[172:175], v[124:127]
    ds_read_b64_tr_b16 v[224:225], v245 offset:8192
    v_mfma_f32_16x16x32_bf16 v[140:143], v[188:191], v[176:179], v[140:143]
    ds_read_b64_tr_b16 v[226:227], v245 offset:9216
    v_mfma_f32_16x16x32_bf16 v[156:159], v[188:191], v[180:183], v[156:159]
    ds_read_b64_tr_b16 v[232:233], v247 offset:8192
    v_mfma_f32_16x16x32_bf16 v[164:167], v[196:199], v[180:183], v[164:167]
    ds_read_b64_tr_b16 v[234:235], v247 offset:9216
    v_mfma_f32_16x16x32_bf16 v[148:151], v[196:199], v[176:179], v[148:151]
    ds_read_b64_tr_b16 v[236:237], v248 offset:2048
    v_mfma_f32_16x16x32_bf16 v[132:135], v[196:199], v[172:175], v[132:135]
    ds_read_b64_tr_b16 v[238:239], v248 offset:2304
    v_mfma_f32_16x16x32_bf16 v[116:119], v[196:199], v[168:171], v[116:119]
    v_mfma_f32_16x16x32_bf16 v[32:35], v[200:203], v[168:171], v[32:35]
    v_mfma_f32_16x16x32_bf16 v[36:39], v[200:203], v[172:175], v[36:39]
    s_waitcnt lgkmcnt(8)
    v_mfma_f32_16x16x32_bf16 v[104:107], v[220:223], v[204:207], v[104:107]
    v_mfma_f32_16x16x32_bf16 v[120:123], v[220:223], v[208:211], v[120:123]
    v_mfma_f32_16x16x32_bf16 v[136:139], v[220:223], v[212:215], v[136:139]
    s_cbranch_vccz L_e5
    s_waitcnt vmcnt(3) lgkmcnt(0)
L_e5_r:
    s_barrier
    s_cbranch_vccnz L_d6
L_d6_r:
    v_mfma_f32_16x16x32_bf16 v[152:155], v[220:223], v[216:219], v[152:155]
    ds_read_b64_tr_b16 v[184:185], v244 offset:16384
    v_mfma_f32_16x16x32_bf16 v[160:163], v[228:231], v[216:219], v[160:163]
    ds_read_b64_tr_b16 v[186:187], v244 offset:17408
    v_mfma_f32_16x16x32_bf16 v[144:147], v[228:231], v[212:215], v[144:147]
    ds_read_b128 v[168:171], v240 offset:16384
    v_mfma_f32_16x16x32_bf16 v[128:131], v[228:231], v[208:211], v[128:131]
    ds_read_b128 v[172:175], v240 offset:18432
    v_mfma_f32_16x16x32_bf16 v[112:115], v[228:231], v[204:207], v[112:115]
    ds_read_b128 v[176:179], v241 offset:16384
    v_mfma_f32_16x16x32_bf16 v[108:111], v[224:227], v[204:207], v[108:111]
    ds_read_b128 v[180:183], v241 offset:18432
    v_mfma_f32_16x16x32_bf16 v[124:127], v[224:227], v[208:211], v[124:127]
    ds_read_b64_tr_b16 v[192:193], v246 offset:16384
    v_mfma_f32_16x16x32_bf16 v[140:143], v[224:227], v[212:215], v[140:143]
    ds_read_b64_tr_b16 v[194:195], v246 offset:17408
    v_mfma_f32_16x16x32_bf16 v[156:159], v[224:227], v[216:219], v[156:159]
    ds_read_b64_tr_b16 v[188:189], v245 offset:16384
    v_mfma_f32_16x16x32_bf16 v[164:167], v[232:235], v[216:219], v[164:167]
    ds_read_b64_tr_b16 v[190:191], v245 offset:17408
    v_mfma_f32_16x16x32_bf16 v[148:151], v[232:235], v[212:215], v[148:151]
    ds_read_b64_tr_b16 v[196:197], v247 offset:16384
    v_mfma_f32_16x16x32_bf16 v[132:135], v[232:235], v[208:211], v[132:135]
    ds_read_b64_tr_b16 v[198:199], v247 offset:17408
    v_mfma_f32_16x16x32_bf16 v[116:119], v[232:235], v[204:207], v[116:119]
    ds_read_b64_tr_b16 v[200:201], v248 offset:4096
    v_mfma_f32_16x16x32_bf16 v[32:35], v[236:239], v[204:207], v[32:35]
    ds_read_b64_tr_b16 v[202:203], v248 offset:4352
    v_mfma_f32_16x16x32_bf16 v[36:39], v[236:239], v[208:211], v[36:39]
    s_waitcnt lgkmcnt(6)
    v_mfma_f32_16x16x32_bf16 v[104:107], v[184:187], v[168:171], v[104:107]
    ds_read_b64_tr_b16 v[220:221], v244 offset:24576
    v_mfma_f32_16x16x32_bf16 v[120:123], v[184:187], v[172:175], v[120:123]
    ds_read_b64_tr_b16 v[222:223], v244 offset:25600
    v_mfma_f32_16x16x32_bf16 v[136:139], v[184:187], v[176:179], v[136:139]
    ds_read_b128 v[204:207], v242 offset:16384
    v_mfma_f32_16x16x32_bf16 v[152:155], v[184:187], v[180:183], v[152:155]
    ds_read_b128 v[208:211], v242 offset:18432
    v_mfma_f32_16x16x32_bf16 v[160:163], v[192:195], v[180:183], v[160:163]
    ds_read_b128 v[212:215], v243 offset:16384
    v_mfma_f32_16x16x32_bf16 v[144:147], v[192:195], v[176:179], v[144:147]
    ds_read_b128 v[216:219], v243 offset:18432
    v_mfma_f32_16x16x32_bf16 v[128:131], v[192:195], v[172:175], v[128:131]
    ds_read_b64_tr_b16 v[228:229], v246 offset:24576
    v_mfma_f32_16x16x32_bf16 v[112:115], v[192:195], v[168:171], v[112:115]
    s_waitcnt lgkmcnt(7)
    v_mfma_f32_16x16x32_bf16 v[108:111], v[188:191], v[168:171], v[108:111]
    ds_read_b64_tr_b16 v[230:231], v246 offset:25600
    v_mfma_f32_16x16x32_bf16 v[124:127], v[188:191], v[172:175], v[124:127]
    ds_read_b64_tr_b16 v[224:225], v245 offset:24576
    v_mfma_f32_16x16x32_bf16 v[140:143], v[188:191], v[176:179], v[140:143]
    ds_read_b64_tr_b16 v[226:227], v245 offset:25600
    v_mfma_f32_16x16x32_bf16 v[156:159], v[188:191], v[180:183], v[156:159]
    ds_read_b64_tr_b16 v[232:233], v247 offset:24576
    v_mfma_f32_16x16x32_bf16 v[164:167], v[196:199], v[180:183], v[164:167]
    ds_read_b64_tr_b16 v[234:235], v247 offset:25600
    v_mfma_f32_16x16x32_bf16 v[148:151], v[196:199], v[176:179], v[148:151]
    ds_read_b64_tr_b16 v[236:237], v248 offset:6144
    v_mfma_f32_16x16x32_bf16 v[132:135], v[196:199], v[172:175], v[132:135]
    ds_read_b64_tr_b16 v[238:239], v248 offset:6400
    v_mfma_f32_16x16x32_bf16 v[116:119], v[196:199], v[168:171], v[116:119]
    v_mfma_f32_16x16x32_bf16 v[32:35], v[200:203], v[168:171], v[32:35]
    v_mfma_f32_16x16x32_bf16 v[36:39], v[200:203], v[172:175], v[36:39]
    s_waitcnt lgkmcnt(8)
    v_mfma_f32_16x16x32_bf16 v[104:107], v[220:223], v[204:207], v[104:107]
    v_mfma_f32_16x16x32_bf16 v[120:123], v[220:223], v[208:211], v[120:123]
    v_mfma_f32_16x16x32_bf16 v[136:139], v[220:223], v[212:215], v[136:139]
    s_cbranch_vccz L_e6
    s_waitcnt vmcnt(5) lgkmcnt(0)
L_e6_r:
    s_barrier
    s_cbranch_vccnz L_d7
L_d7_r:
    v_mfma_f32_16x16x32_bf16 v[152:155], v[220:223], v[216:219], v[152:155]
    ds_read_b64_tr_b16 v[184:185], v244 offset:32768
    v_mfma_f32_16x16x32_bf16 v[160:163], v[228:231], v[216:219], v[160:163]
    ds_read_b64_tr_b16 v[186:187], v244 offset:33792
    v_mfma_f32_16x16x32_bf16 v[144:147], v[228:231], v[212:215], v[144:147]
    ds_read_b128 v[168:171], v240 offset:32768
    v_mfma_f32_16x16x32_bf16 v[128:131], v[228:231], v[208:211], v[128:131]
    ds_read_b128 v[172:175], v240 offset:34816
    v_mfma_f32_16x16x32_bf16 v[112:115], v[228:231], v[204:207], v[112:115]
    ds_read_b128 v[176:179], v241 offset:32768
    v_mfma_f32_16x16x32_bf16 v[108:111], v[224:227], v[204:207], v[108:111]
    ds_read_b128 v[180:183], v241 offset:34816
    v_mfma_f32_16x16x32_bf16 v[124:127], v[224:227], v[208:211], v[124:127]
    ds_read_b64_tr_b16 v[192:193], v246 offset:32768
    v_mfma_f32_16x16x32_bf16 v[140:143], v[224:227], v[212:215], v[140:143]
    ds_read_b64_tr_b16 v[194:195], v246 offset:33792
    v_mfma_f32_16x16x32_bf16 v[156:159], v[224:227], v[216:219], v[156:159]
    ds_read_b64_tr_b16 v[188:189], v245 offset:32768
    v_mfma_f32_16x16x32_bf16 v[164:167], v[232:235], v[216:219], v[164:167]
    ds_read_b64_tr_b16 v[190:191], v245 offset:33792
    v_mfma_f32_16x16x32_bf16 v[148:151], v[232:235], v[212:215], v[148:151]
    ds_read_b64_tr_b16 v[196:197], v247 offset:32768
    v_mfma_f32_16x16x32_bf16 v[132:135], v[232:235], v[208:211], v[132:135]
    ds_read_b64_tr_b16 v[198:199], v247 offset:33792
    v_mfma_f32_16x16x32_bf16 v[116:119], v[232:235], v[204:207], v[116:119]
    ds_read_b64_tr_b16 v[200:201], v248 offset:8192
    v_mfma_f32_16x16x32_bf16 v[32:35], v[236:239], v[204:207], v[32:35]
    ds_read_b64_tr_b16 v[202:203], v248 offset:8448
    v_mfma_f32_16x16x32_bf16 v[36:39], v[236:239], v[208:211], v[36:39]
    s_waitcnt lgkmcnt(6)
    v_mfma_f32_16x16x32_bf16 v[104:107], v[184:187], v[168:171], v[104:107]
    ds_read_b64_tr_b16 v[220:221], v244 offset:40960
    v_mfma_f32_16x16x32_bf16 v[120:123], v[184:187], v[172:175], v[120:123]
    ds_read_b64_tr_b16 v[222:223], v244 offset:41984
    v_mfma_f32_16x16x32_bf16 v[136:139], v[184:187], v[176:179], v[136:139]
    ds_read_b128 v[204:207], v242 offset:32768
    v_mfma_f32_16x16x32_bf16 v[152:155], v[184:187], v[180:183], v[152:155]
    ds_read_b128 v[208:211], v242 offset:34816
    v_mfma_f32_16x16x32_bf16 v[160:163], v[192:195], v[180:183], v[160:163]
    ds_read_b128 v[212:215], v243 offset:32768
    v_mfma_f32_16x16x32_bf16 v[144:147], v[192:195], v[176:179], v[144:147]
    ds_read_b128 v[216:219], v243 offset:34816
    v_mfma_f32_16x16x32_bf16 v[128:131], v[192:195], v[172:175], v[128:131]
    ds_read_b64_tr_b16 v[228:229], v246 offset:40960
    v_mfma_f32_16x16x32_bf16 v[112:115], v[192:195], v[168:171], v[112:115]
    s_waitcnt lgkmcnt(7)
    v_mfma_f32_16x16x32_bf16 v[108:111], v[188:191], v[168:171], v[108:111]
    ds_read_b64_tr_b16 v[230:231], v246 offset:41984
    v_mfma_f32_16x16x32_bf16 v[124:127], v[188:191], v[172:175], v[124:127]
    ds_read_b64_tr_b16 v[224:225], v245 offset:40960
    v_mfma_f32_16x16x32_bf16 v[140:143], v[188:191], v[176:179], v[140:143]
    ds_read_b64_tr_b16 v[226:227], v245 offset:41984
    v_mfma_f32_16x16x32_bf16 v[156:159], v[188:191], v[180:183], v[156:159]
    ds_read_b64_tr_b16 v[232:233], v247 offset:40960
    v_mfma_f32_16x16x32_bf16 v[164:167], v[196:199], v[180:183], v[164:167]
    ds_read_b64_tr_b16 v[234:235], v247 offset:41984
    v_mfma_f32_16x16x32_bf16 v[148:151], v[196:199], v[176:179], v[148:151]
    ds_read_b64_tr_b16 v[236:237], v248 offset:10240
    v_mfma_f32_16x16x32_bf16 v[132:135], v[196:199], v[172:175], v[132:135]
    ds_read_b64_tr_b16 v[238:239], v248 offset:10496
    v_mfma_f32_16x16x32_bf16 v[116:119], v[196:199], v[168:171], v[116:119]
    v_mfma_f32_16x16x32_bf16 v[32:35], v[200:203], v[168:171], v[32:35]
    v_mfma_f32_16x16x32_bf16 v[36:39], v[200:203], v[172:175], v[36:39]
    s_waitcnt lgkmcnt(8)
    v_mfma_f32_16x16x32_bf16 v[104:107], v[220:223], v[204:207], v[104:107]
    v_mfma_f32_16x16x32_bf16 v[120:123], v[220:223], v[208:211], v[120:123]
    v_mfma_f32_16x16x32_bf16 v[136:139], v[220:223], v[212:215], v[136:139]
    s_cbranch_vccz L_e7
    s_waitcnt vmcnt(7) lgkmcnt(0)
L_e7_r:
    s_barrier
    v_mfma_f32_16x16x32_bf16 v[152:155], v[220:223], v[216:219], v[152:155]
    ds_read_b64_tr_b16 v[184:185], v244 offset:0
    v_mfma_f32_16x16x32_bf16 v[160:163], v[228:231], v[216:219], v[160:163]
    ds_read_b64_tr_b16 v[186:187], v244 offset:1024
    v_mfma_f32_16x16x32_bf16 v[144:147], v[228:231], v[212:215], v[144:147]
    ds_read_b128 v[168:171], v240 offset:0
    v_mfma_f32_16x16x32_bf16 v[128:131], v[228:231], v[208:211], v[128:131]
    ds_read_b128 v[172:175], v240 offset:2048
    v_mfma_f32_16x16x32_bf16 v[112:115], v[228:231], v[204:207], v[112:115]
    ds_read_b128 v[176:179], v241 offset:0
    v_mfma_f32_16x16x32_bf16 v[108:111], v[224:227], v[204:207], v[108:111]
    ds_read_b128 v[180:183], v241 offset:2048
    v_mfma_f32_16x16x32_bf16 v[124:127], v[224:227], v[208:211], v[124:127]
    ds_read_b64_tr_b16 v[192:193], v246 offset:0
    v_mfma_f32_16x16x32_bf16 v[140:143], v[224:227], v[212:215], v[140:143]
    ds_read_b64_tr_b16 v[194:195], v246 offset:1024
    v_mfma_f32_16x16x32_bf16 v[156:159], v[224:227], v[216:219], v[156:159]
    ds_read_b64_tr_b16 v[188:189], v245 offset:0
    v_mfma_f32_16x16x32_bf16 v[164:167], v[232:235], v[216:219], v[164:167]
    ds_read_b64_tr_b16 v[190:191], v245 offset:1024
    v_mfma_f32_16x16x32_bf16 v[148:151], v[232:235], v[212:215], v[148:151]
    ds_read_b64_tr_b16 v[196:197], v247 offset:0
    v_mfma_f32_16x16x32_bf16 v[132:135], v[232:235], v[208:211], v[132:135]
    ds_read_b64_tr_b16 v[198:199], v247 offset:1024
    v_mfma_f32_16x16x32_bf16 v[116:119], v[232:235], v[204:207], v[116:119]
    ds_read_b64_tr_b16 v[200:201], v248 offset:0
    v_mfma_f32_16x16x32_bf16 v[32:35], v[236:239], v[204:207], v[32:35]
    ds_read_b64_tr_b16 v[202:203], v248 offset:256
    v_mfma_f32_16x16x32_bf16 v[36:39], v[236:239], v[208:211], v[36:39]
    s_cbranch_vccnz L_st6
    s_setprio 0
    s_cmp_lg_u32 s50, 4
    s_cbranch_scc1 L_nopoll
    buffer_load_dword v14, off, s[36:39], 0 sc1
L_nopoll:
    s_lshl_b32 s68, s53, 2
    s_add_u32 s68, s68, s52
    s_mul_i32 s69, s68, 112
    s_lshl_b32 s70, s54, 3
    s_add_u32 s69, s69, s70
    s_lshl_b32 s70, s51, 2
    s_add_u32 s69, s69, s70
    s_and_b32 s70, s52, 1
    s_lshl_b32 s70, s70, 1
    s_add_u32 s69, s69, s70
    s_lshl_b32 s69, s69, 10
    s_add_u32 s80, s69, 0x400000
    s_mul_i32 s70, s70, 114688
    s_sub_u32 s70, 114688, s70
    s_add_u32 s3, s80, s70
    v_bfe_u32 v2, v0, 2, 2
    v_lshrrev_b32 v3, 5, v0
    v_lshl_add_u32 v2, v3, 2, v2
    v_lshlrev_b32 v2, 6, v2
    v_bfe_u32 v3, v0, 4, 1
    v_lshl_add_u32 v2, v3, 5, v2
    v_and_b32 v3, 3, v0
    v_lshl_add_u32 v2, v3, 3, v2
    s_lshr_b32 s68, s50, 1
    s_lshl_b32 s68, s68, 11
    v_add_u32 v9, s68, v2
    v_add_u32 v8, 0x20000, v1
    v_add_u32 v29, 0x24000, v1
    v_bfe_u32 v2, v0, 2, 3
    v_lshlrev_b32 v2, 10, v2
    v_lshrrev_b32 v3, 5, v0
    v_lshl_add_u32 v2, v3, 6, v2
    v_and_b32 v3, 3, v0
    v_lshl_add_u32 v2, v3, 4, v2
    s_lshl_b32 s69, s56, 7
    v_add_u32 v10, s69, v2
    v_min_u32 v2, 13, v0
    v_lshlrev_b32 v2, 7, v2
    s_lshr_b32 s68, s55, 1
    s_lshl_b32 s68, s68, 11
    s_add_u32 s68, s68, 0x30000
    v_add_u32 v13, s68, v2
    s_lshl_b32 s68, s55, 1
    s_and_b32 s69, s50, 1
    s_add_u32 s68, s68, s69
    s_lshl_b32 s69, s68, 15
    s_lshr_b32 s76, s50, 1
    s_and_b32 s76, s50, 2
    s_add_u32 s76, s76, s51
    s_lshl_b32 s70, s76, 13
    s_add_u32 s69, s69, s70
    s_add_u32 s79, s69, 0x100000
    v_and_b32 v2, 31, v0
    v_lshrrev_b32 v3, 5, v0
    v_and_b32 v4, 7, v0
    v_xor_b32 v3, v3, v4
    v_lshlrev_b32 v3, 4, v3
    v_lshl_add_u32 v3, v2, 8, v3
    s_and_b32 s69, s50, 1
    s_lshl_b32 s69, s69, 15
    s_lshr_b32 s70, s50, 1
    s_lshl_b32 s71, s70, 13
    s_add_u32 s59, s71, s69
    s_add_u32 s71, s59, 0x18000
    v_add_u32 v30, s71, v3
    v_lshrrev_b32 v2, 3, v0
    v_lshlrev_b32 v3, 1, v4
    v_xor_b32 v3, v3, v2
    v_lshlrev_b32 v3, 4, v3
    v_lshl_add_u32 v3, v2, 8, v3
    s_lshl_b32 s71, s70, 11
    s_add_u32 s71, s71, s69
    s_add_u32 s71, s71, 0x18000
    v_add_u32 v31, s71, v3
    v_lshlrev_b32 v4, 4, v4
    v_lshl_add_u32 v12, v2, 10, v4
    s_lshl_b32 s70, s55, 16
    s_add_u32 s59, s59, s70
    s_lshl_b32 s70, s56, 7
    s_add_u32 s59, s59, s70
    s_waitcnt vmcnt(0)
    s_cmp_lg_u32 s50, 4
    s_cbranch_scc1 L_kvf_done
    s_mov_b32 s69, 0x4000
    s_branch L_kvf_chk
L_kvf_re:
    buffer_load_dword v14, off, s[36:39], 0 sc1
    s_waitcnt vmcnt(0)
L_kvf_chk:
    v_readfirstlane_b32 s68, v14
    s_cmp_ge_u32 s68, 32
    s_cbranch_scc1 L_kvf_done
    s_sleep 4
    s_sub_u32 s69, s69, 1
    s_cmp_lg_u32 s69, 0
    s_cbranch_scc1 L_kvf_re
L_kvf_done:
    s_barrier
    s_add_u32 m0, s58, 0x20000
    s_add_u32 s68, s58, 0x0
    buffer_load_dwordx4 v1, s[64:67], s68 offen sc1 lds
    s_add_u32 m0, s58, 0x21000
    s_add_u32 s68, s58, 0x1000
    buffer_load_dwordx4 v1, s[64:67], s68 offen sc1 lds
    s_add_u32 m0, s58, 0x22000
    s_add_u32 s68, s58, 0x2000
    buffer_load_dwordx4 v1, s[64:67], s68 offen sc1 lds
    s_add_u32 m0, s58, 0x23000
    s_add_u32 s68, s58, 0x3000
    buffer_load_dwordx4 v1, s[64:67], s68 offen sc1 lds
    s_mov_b32 s68, 0x1f800
    buffer_load_dwordx4 v[20:23], v1, s[64:67], s68 offen sc1
    s_mov_b64 exec, s[60:61]
    buffer_load_dwordx4 v[24:27], v1, s[64:67], 0 offen offset:1280 sc1
    s_mov_b64 exec, -1
    s_lshl_b32 s68, s53, 2
    s_add_u32 s68, s68, s52
    s_lshl_b32 s68, s68, 7
    s_add_u32 s68, s68, 0x20000
    buffer_load_dword v6, v15, s[20:23], s68 offen sc1
    s_lshl_b32 s68, s55, 1
    s_and_b32 s69, s50, 1
    s_add_u32 s68, s68, s69
    s_lshl_b32 s68, s68, 7
    s_add_u32 s68, s68, 0x20000
    buffer_load_dword v7, v15, s[20:23], s68 offen sc1
    buffer_store_dwordx4 v[16:19], v1, s[20:23], s78 offen sc1
    v_mov_b32 v28, 0xdddd
    v_lshrrev_b32 v2, 4, v0
    v_lshl_add_u32 v254, v2, 8, v1
    v_mov_b32 v56, 0
    v_mov_b32 v57, 0
    v_mov_b32 v58, 0
    v_mov_b32 v59, 0
    v_mov_b32 v60, 0
    v_mov_b32 v61, 0
    v_mov_b32 v62, 0
    v_mov_b32 v63, 0
    v_mov_b32 v64, 0
    v_mov_b32 v65, 0
    v_mov_b32 v66, 0
    v_mov_b32 v67, 0
    v_mov_b32 v68, 0
    v_mov_b32 v69, 0
    v_mov_b32 v70, 0
    v_mov_b32 v71, 0
    v_mov_b32 v72, 0
    v_mov_b32 v73, 0
    v_mov_b32 v74, 0
    v_mov_b32 v75, 0
    v_mov_b32 v76, 0
    v_mov_b32 v77, 0
    v_mov_b32 v78, 0
    v_mov_b32 v79, 0
    v_mov_b32 v80, 0
    v_mov_b32 v81, 0
    v_mov_b32 v82, 0
    v_mov_b32 v83, 0
    v_mov_b32 v84, 0
    v_mov_b32 v85, 0
    v_mov_b32 v86, 0
    v_mov_b32 v87, 0
    v_mov_b32 v88, 0
    v_mov_b32 v89, 0
    v_mov_b32 v90, 0
    v_mov_b32 v91, 0
    v_mov_b32 v92, 0
    v_mov_b32 v93, 0
    v_mov_b32 v94, 0
    v_mov_b32 v95, 0
    v_mov_b32 v96, 0
    v_mov_b32 v97, 0
    v_mov_b32 v98, 0
    v_mov_b32 v99, 0
    v_mov_b32 v100, 0
    v_mov_b32 v101, 0
    v_mov_b32 v102, 0
    v_mov_b32 v103, 0
    v_mov_b32 v252, 0xc0135761
    v_mov_b32 v253, 0xbdd2d3e8
L_st6:
    s_waitcnt lgkmcnt(6)
    v_mfma_f32_16x16x32_bf16 v[104:107], v[184:187], v[168:171], v[104:107]
    ds_read_b64_tr_b16 v[220:221], v244 offset:8192
    v_mfma_f32_16x16x32_bf16 v[120:123], v[184:187], v[172:175], v[120:123]
    ds_read_b64_tr_b16 v[222:223], v244 offset:9216
    v_mfma_f32_16x16x32_bf16 v[136:139], v[184:187], v[176:179], v[136:139]
    ds_read_b128 v[204:207], v242 offset:0
    v_mfma_f32_16x16x32_bf16 v[152:155], v[184:187], v[180:183], v[152:155]
    ds_read_b128 v[208:211], v242 offset:2048
    v_mfma_f32_16x16x32_bf16 v[160:163], v[192:195], v[180:183], v[160:163]
    ds_read_b128 v[212:215], v243 offset:0
    v_mfma_f32_16x16x32_bf16 v[144:147], v[192:195], v[176:179], v[144:147]
    ds_read_b128 v[216:219], v243 offset:2048
    v_mfma_f32_16x16x32_bf16 v[128:131], v[192:195], v[172:175], v[128:131]
    ds_read_b64_tr_b16 v[228:229], v246 offset:8192
    v_mfma_f32_16x16x32_bf16 v[112:115], v[192:195], v[168:171], v[112:115]
    s_waitcnt lgkmcnt(7)
    v_mfma_f32_16x16x32_bf16 v[108:111], v[188:191], v[168:171], v[108:111]
    ds_read_b64_tr_b16 v[230:231], v246 offset:9216
    v_mfma_f32_16x16x32_bf16 v[124:127], v[188:191], v[172:175], v[124:127]
    ds_read_b64_tr_b16 v[224:225], v245 offset:8192
    v_mfma_f32_16x16x32_bf16 v[140:143], v[188:191], v[176:179], v[140:143]
    ds_read_b64_tr_b16 v[226:227], v245 offset:9216
    v_mfma_f32_16x16x32_bf16 v[156:159], v[188:191], v[180:183], v[156:159]
    ds_read_b64_tr_b16 v[232:233], v247 offset:8192
    v_mfma_f32_16x16x32_bf16 v[164:167], v[196:199], v[180:183], v[164:167]
    ds_read_b64_tr_b16 v[234:235], v247 offset:9216
    v_mfma_f32_16x16x32_bf16 v[148:151], v[196:199], v[176:179], v[148:151]
    ds_read_b64_tr_b16 v[236:237], v248 offset:2048
    v_mfma_f32_16x16x32_bf16 v[132:135], v[196:199], v[172:175], v[132:135]
    ds_read_b64_tr_b16 v[238:239], v248 offset:2304
    v_mfma_f32_16x16x32_bf16 v[116:119], v[196:199], v[168:171], v[116:119]
    v_mfma_f32_16x16x32_bf16 v[32:35], v[200:203], v[168:171], v[32:35]
    v_mfma_f32_16x16x32_bf16 v[36:39], v[200:203], v[172:175], v[36:39]
    s_waitcnt lgkmcnt(8)
    v_mfma_f32_16x16x32_bf16 v[104:107], v[220:223], v[204:207], v[104:107]
    v_mfma_f32_16x16x32_bf16 v[120:123], v[220:223], v[208:211], v[120:123]
    v_mfma_f32_16x16x32_bf16 v[136:139], v[220:223], v[212:215], v[136:139]
    s_waitcnt lgkmcnt(0)
    s_cbranch_vccz L_st7
    s_setprio 1
    s_waitcnt vmcnt(0)
    s_barrier
L_st7:
    v_mfma_f32_16x16x32_bf16 v[152:155], v[220:223], v[216:219], v[152:155]
    ds_read_b64_tr_b16 v[184:185], v244 offset:16384
    v_mfma_f32_16x16x32_bf16 v[160:163], v[228:231], v[216:219], v[160:163]
    ds_read_b64_tr_b16 v[186:187], v244 offset:17408
    v_mfma_f32_16x16x32_bf16 v[144:147], v[228:231], v[212:215], v[144:147]
    ds_read_b128 v[168:171], v240 offset:16384
    v_mfma_f32_16x16x32_bf16 v[128:131], v[228:231], v[208:211], v[128:131]
    ds_read_b128 v[172:175], v240 offset:18432
    v_mfma_f32_16x16x32_bf16 v[112:115], v[228:231], v[204:207], v[112:115]
    ds_read_b128 v[176:179], v241 offset:16384
    v_mfma_f32_16x16x32_bf16 v[108:111], v[224:227], v[204:207], v[108:111]
    ds_read_b128 v[180:183], v241 offset:18432
    v_mfma_f32_16x16x32_bf16 v[124:127], v[224:227], v[208:211], v[124:127]
    ds_read_b64_tr_b16 v[192:193], v246 offset:16384
    v_mfma_f32_16x16x32_bf16 v[140:143], v[224:227], v[212:215], v[140:143]
    ds_read_b64_tr_b16 v[194:195], v246 offset:17408
    v_mfma_f32_16x16x32_bf16 v[156:159], v[224:227], v[216:219], v[156:159]
    ds_read_b64_tr_b16 v[188:189], v245 offset:16384
    v_mfma_f32_16x16x32_bf16 v[164:167], v[232:235], v[216:219], v[164:167]
    ds_read_b64_tr_b16 v[190:191], v245 offset:17408
    v_mfma_f32_16x16x32_bf16 v[148:151], v[232:235], v[212:215], v[148:151]
    ds_read_b64_tr_b16 v[196:197], v247 offset:16384
    v_mfma_f32_16x16x32_bf16 v[132:135], v[232:235], v[208:211], v[132:135]
    ds_read_b64_tr_b16 v[198:199], v247 offset:17408
    v_mfma_f32_16x16x32_bf16 v[116:119], v[232:235], v[204:207], v[116:119]
    ds_read_b64_tr_b16 v[200:201], v248 offset:4096
    v_mfma_f32_16x16x32_bf16 v[32:35], v[236:239], v[204:207], v[32:35]
    ds_read_b64_tr_b16 v[202:203], v248 offset:4352
    v_mfma_f32_16x16x32_bf16 v[36:39], v[236:239], v[208:211], v[36:39]
    s_waitcnt lgkmcnt(6)
    v_mfma_f32_16x16x32_bf16 v[104:107], v[184:187], v[168:171], v[104:107]
    ds_read_b64_tr_b16 v[220:221], v244 offset:24576
    v_mfma_f32_16x16x32_bf16 v[120:123], v[184:187], v[172:175], v[120:123]
    ds_read_b64_tr_b16 v[222:223], v244 offset:25600
    v_mfma_f32_16x16x32_bf16 v[136:139], v[184:187], v[176:179], v[136:139]
    ds_read_b128 v[204:207], v242 offset:16384
    v_mfma_f32_16x16x32_bf16 v[152:155], v[184:187], v[180:183], v[152:155]
    ds_read_b128 v[208:211], v242 offset:18432
    v_mfma_f32_16x16x32_bf16 v[160:163], v[192:195], v[180:183], v[160:163]
    ds_read_b128 v[212:215], v243 offset:16384
    v_mfma_f32_16x16x32_bf16 v[144:147], v[192:195], v[176:179], v[144:147]
    ds_read_b128 v[216:219], v243 offset:18432
    v_mfma_f32_16x16x32_bf16 v[128:131], v[192:195], v[172:175], v[128:131]
    ds_read_b64_tr_b16 v[228:229], v246 offset:24576
    v_mfma_f32_16x16x32_bf16 v[112:115], v[192:195], v[168:171], v[112:115]
    s_waitcnt lgkmcnt(7)
    v_mfma_f32_16x16x32_bf16 v[108:111], v[188:191], v[168:171], v[108:111]
    ds_read_b64_tr_b16 v[230:231], v246 offset:25600
    v_mfma_f32_16x16x32_bf16 v[124:127], v[188:191], v[172:175], v[124:127]
    ds_read_b64_tr_b16 v[224:225], v245 offset:24576
    v_mfma_f32_16x16x32_bf16 v[140:143], v[188:191], v[176:179], v[140:143]
    ds_read_b64_tr_b16 v[226:227], v245 offset:25600
    v_mfma_f32_16x16x32_bf16 v[156:159], v[188:191], v[180:183], v[156:159]
    ds_read_b64_tr_b16 v[232:233], v247 offset:24576
    v_mfma_f32_16x16x32_bf16 v[164:167], v[196:199], v[180:183], v[164:167]
    ds_read_b64_tr_b16 v[234:235], v247 offset:25600
    v_mfma_f32_16x16x32_bf16 v[148:151], v[196:199], v[176:179], v[148:151]
    ds_read_b64_tr_b16 v[236:237], v248 offset:6144
    v_mfma_f32_16x16x32_bf16 v[132:135], v[196:199], v[172:175], v[132:135]
    ds_read_b64_tr_b16 v[238:239], v248 offset:6400
    v_mfma_f32_16x16x32_bf16 v[116:119], v[196:199], v[168:171], v[116:119]
    v_mfma_f32_16x16x32_bf16 v[32:35], v[200:203], v[168:171], v[32:35]
    v_mfma_f32_16x16x32_bf16 v[36:39], v[200:203], v[172:175], v[36:39]
    s_waitcnt lgkmcnt(8)
    v_mfma_f32_16x16x32_bf16 v[104:107], v[220:223], v[204:207], v[104:107]
    v_mfma_f32_16x16x32_bf16 v[120:123], v[220:223], v[208:211], v[120:123]
    v_mfma_f32_16x16x32_bf16 v[136:139], v[220:223], v[212:215], v[136:139]
    s_waitcnt lgkmcnt(0)
    v_mfma_f32_16x16x32_bf16 v[152:155], v[220:223], v[216:219], v[152:155]
    v_mfma_f32_16x16x32_bf16 v[160:163], v[228:231], v[216:219], v[160:163]
    v_mfma_f32_16x16x32_bf16 v[144:147], v[228:231], v[212:215], v[144:147]
    v_mfma_f32_16x16x32_bf16 v[128:131], v[228:231], v[208:211], v[128:131]
    v_mfma_f32_16x16x32_bf16 v[112:115], v[228:231], v[204:207], v[112:115]
    v_mfma_f32_16x16x32_bf16 v[108:111], v[224:227], v[204:207], v[108:111]
    v_mfma_f32_16x16x32_bf16 v[124:127], v[224:227], v[208:211], v[124:127]
    v_mfma_f32_16x16x32_bf16 v[140:143], v[224:227], v[212:215], v[140:143]
    v_mfma_f32_16x16x32_bf16 v[156:159], v[224:227], v[216:219], v[156:159]
    v_mfma_f32_16x16x32_bf16 v[164:167], v[232:235], v[216:219], v[164:167]
    v_mfma_f32_16x16x32_bf16 v[148:151], v[232:235], v[212:215], v[148:151]
    v_mfma_f32_16x16x32_bf16 v[132:135], v[232:235], v[208:211], v[132:135]
    v_mfma_f32_16x16x32_bf16 v[116:119], v[232:235], v[204:207], v[116:119]
    v_mfma_f32_16x16x32_bf16 v[32:35], v[236:239], v[204:207], v[32:35]
    v_mfma_f32_16x16x32_bf16 v[36:39], v[236:239], v[208:211], v[36:39]
L_join:
    s_cmp_eq_u32 s51, 0
    s_cbranch_scc1 L_trA
    s_waitcnt vmcnt(1)
    s_setprio 1
    s_cmp_ge_u32 s54, 14
.p2align 3
    s_barrier
    s_cbranch_scc1 L_nogB
    v_pk_mul_f32 v[184:185], v[104:105], v[104:105]
    v_pk_mul_f32 v[186:187], v[106:107], v[106:107]
    v_pk_mul_f32 v[188:189], v[108:109], v[108:109]
    v_pk_mul_f32 v[190:191], v[110:111], v[110:111]
    v_pk_fma_f32 v[184:185], v[184:185], v[252:253], v[252:253] op_sel:[0,1,0] op_sel_hi:[1,1,0]
    v_pk_fma_f32 v[186:187], v[186:187], v[252:253], v[252:253] op_sel:[0,1,0] op_sel_hi:[1,1,0]
    v_pk_fma_f32 v[188:189], v[188:189], v[252:253], v[252:253] op_sel:[0,1,0] op_sel_hi:[1,1,0]
    v_pk_fma_f32 v[190:191], v[190:191], v[252:253], v[252:253] op_sel:[0,1,0] op_sel_hi:[1,1,0]
    v_pk_mul_f32 v[184:185], v[184:185], v[104:105]
    v_pk_mul_f32 v[186:187], v[186:187], v[106:107]
    v_pk_mul_f32 v[188:189], v[188:189], v[108:109]
    v_pk_mul_f32 v[190:191], v[190:191], v[110:111]
    v_exp_f32 v184, v184
    v_exp_f32 v185, v185
    v_exp_f32 v186, v186
    v_exp_f32 v187, v187
    v_exp_f32 v188, v188
    v_exp_f32 v189, v189
    v_exp_f32 v190, v190
    v_exp_f32 v191, v191
    v_pk_add_f32 v[184:185], v[184:185], 1.0 op_sel_hi:[1,0]
    v_pk_add_f32 v[186:187], v[186:187], 1.0 op_sel_hi:[1,0]
    v_pk_add_f32 v[188:189], v[188:189], 1.0 op_sel_hi:[1,0]
    v_pk_add_f32 v[190:191], v[190:191], 1.0 op_sel_hi:[1,0]
    v_rcp_f32 v184, v184
    v_rcp_f32 v185, v185
    v_rcp_f32 v186, v186
    v_rcp_f32 v187, v187
    v_rcp_f32 v188, v188
    v_rcp_f32 v189, v189
    v_rcp_f32 v190, v190
    v_rcp_f32 v191, v191
    v_pk_mul_f32 v[104:105], v[104:105], v[112:113]
    v_pk_mul_f32 v[106:107], v[106:107], v[114:115]
    v_pk_mul_f32 v[108:109], v[108:109], v[116:117]
    v_pk_mul_f32 v[110:111], v[110:111], v[118:119]
    v_pk_mul_f32 v[104:105], v[104:105], v[184:185]
    v_pk_mul_f32 v[106:107], v[106:107], v[186:187]
    v_pk_mul_f32 v[108:109], v[108:109], v[188:189]
    v_pk_mul_f32 v[110:111], v[110:111], v[190:191]
    v_cvt_pk_bf16_f32 v192, v104, v105
    v_cvt_pk_bf16_f32 v193, v106, v107
    v_cvt_pk_bf16_f32 v194, v108, v109
    v_cvt_pk_bf16_f32 v195, v110, v111
    buffer_store_dwordx4 v[192:195], v254, s[20:23], s80 offen offset:0 sc1
    v_pk_mul_f32 v[184:185], v[120:121], v[120:121]
    v_pk_mul_f32 v[186:187], v[122:123], v[122:123]
    v_pk_mul_f32 v[188:189], v[124:125], v[124:125]
    v_pk_mul_f32 v[190:191], v[126:127], v[126:127]
    v_pk_fma_f32 v[184:185], v[184:185], v[252:253], v[252:253] op_sel:[0,1,0] op_sel_hi:[1,1,0]
    v_pk_fma_f32 v[186:187], v[186:187], v[252:253], v[252:253] op_sel:[0,1,0] op_sel_hi:[1,1,0]
    v_pk_fma_f32 v[188:189], v[188:189], v[252:253], v[252:253] op_sel:[0,1,0] op_sel_hi:[1,1,0]
    v_pk_fma_f32 v[190:191], v[190:191], v[252:253], v[252:253] op_sel:[0,1,0] op_sel_hi:[1,1,0]
    v_pk_mul_f32 v[184:185], v[184:185], v[120:121]
    v_pk_mul_f32 v[186:187], v[186:187], v[122:123]
    v_pk_mul_f32 v[188:189], v[188:189], v[124:125]
    v_pk_mul_f32 v[190:191], v[190:191], v[126:127]
    v_exp_f32 v184, v184
    v_exp_f32 v185, v185
    v_exp_f32 v186, v186
    v_exp_f32 v187, v187
    v_exp_f32 v188, v188
    v_exp_f32 v189, v189
    v_exp_f32 v190, v190
    v_exp_f32 v191, v191
    v_pk_add_f32 v[184:185], v[184:185], 1.0 op_sel_hi:[1,0]
    v_pk_add_f32 v[186:187], v[186:187], 1.0 op_sel_hi:[1,0]
    v_pk_add_f32 v[188:189], v[188:189], 1.0 op_sel_hi:[1,0]
    v_pk_add_f32 v[190:191], v[190:191], 1.0 op_sel_hi:[1,0]
    v_rcp_f32 v184, v184
    v_rcp_f32 v185, v185
    v_rcp_f32 v186, v186
    v_rcp_f32 v187, v187
    v_rcp_f32 v188, v188
    v_rcp_f32 v189, v189
    v_rcp_f32 v190, v190
    v_rcp_f32 v191, v191
    v_pk_mul_f32 v[120:121], v[120:121], v[128:129]
    v_pk_mul_f32 v[122:123], v[122:123], v[130:131]
    v_pk_mul_f32 v[124:125], v[124:125], v[132:133]
    v_pk_mul_f32 v[126:127], v[126:127], v[134:135]
    v_pk_mul_f32 v[120:121], v[120:121], v[184:185]
    v_pk_mul_f32 v[122:123], v[122:123], v[186:187]
    v_pk_mul_f32 v[124:125], v[124:125], v[188:189]
    v_pk_mul_f32 v[126:127], v[126:127], v[190:191]
    v_cvt_pk_bf16_f32 v196, v120, v121
    v_cvt_pk_bf16_f32 v197, v122, v123
    v_cvt_pk_bf16_f32 v198, v124, v125
    v_cvt_pk_bf16_f32 v199, v126, v127
    buffer_store_dwordx4 v[196:199], v254, s[20:23], s80 offen offset:256 sc1
    v_pk_mul_f32 v[184:185], v[136:137], v[136:137]
    v_pk_mul_f32 v[186:187], v[138:139], v[138:139]
    v_pk_mul_f32 v[188:189], v[140:141], v[140:141]
    v_pk_mul_f32 v[190:191], v[142:143], v[142:143]
    v_pk_fma_f32 v[184:185], v[184:185], v[252:253], v[252:253] op_sel:[0,1,0] op_sel_hi:[1,1,0]
    v_pk_fma_f32 v[186:187], v[186:187], v[252:253], v[252:253] op_sel:[0,1,0] op_sel_hi:[1,1,0]
    v_pk_fma_f32 v[188:189], v[188:189], v[252:253], v[252:253] op_sel:[0,1,0] op_sel_hi:[1,1,0]
    v_pk_fma_f32 v[190:191], v[190:191], v[252:253], v[252:253] op_sel:[0,1,0] op_sel_hi:[1,1,0]
    v_pk_mul_f32 v[184:185], v[184:185], v[136:137]
    v_pk_mul_f32 v[186:187], v[186:187], v[138:139]
    v_pk_mul_f32 v[188:189], v[188:189], v[140:141]
    v_pk_mul_f32 v[190:191], v[190:191], v[142:143]
    v_exp_f32 v184, v184
    v_exp_f32 v185, v185
    v_exp_f32 v186, v186
    v_exp_f32 v187, v187
    v_exp_f32 v188, v188
    v_exp_f32 v189, v189
    v_exp_f32 v190, v190
    v_exp_f32 v191, v191
    v_pk_add_f32 v[184:185], v[184:185], 1.0 op_sel_hi:[1,0]
    v_pk_add_f32 v[186:187], v[186:187], 1.0 op_sel_hi:[1,0]
    v_pk_add_f32 v[188:189], v[188:189], 1.0 op_sel_hi:[1,0]
    v_pk_add_f32 v[190:191], v[190:191], 1.0 op_sel_hi:[1,0]
    v_rcp_f32 v184, v184
    v_rcp_f32 v185, v185
    v_rcp_f32 v186, v186
    v_rcp_f32 v187, v187
    v_rcp_f32 v188, v188
    v_rcp_f32 v189, v189
    v_rcp_f32 v190, v190
    v_rcp_f32 v191, v191
    v_pk_mul_f32 v[136:137], v[136:137], v[144:145]
    v_pk_mul_f32 v[138:139], v[138:139], v[146:147]
    v_pk_mul_f32 v[140:141], v[140:141], v[148:149]
    v_pk_mul_f32 v[142:143], v[142:143], v[150:151]
    v_pk_mul_f32 v[136:137], v[136:137], v[184:185]
    v_pk_mul_f32 v[138:139], v[138:139], v[186:187]
    v_pk_mul_f32 v[140:141], v[140:141], v[188:189]
    v_pk_mul_f32 v[142:143], v[142:143], v[190:191]
    v_cvt_pk_bf16_f32 v200, v136, v137
    v_cvt_pk_bf16_f32 v201, v138, v139
    v_cvt_pk_bf16_f32 v202, v140, v141
    v_cvt_pk_bf16_f32 v203, v142, v143
    buffer_store_dwordx4 v[200:203], v254, s[20:23], s3 offen offset:0 sc1
    v_pk_mul_f32 v[184:185], v[152:153], v[152:153]
    v_pk_mul_f32 v[186:187], v[154:155], v[154:155]
    v_pk_mul_f32 v[188:189], v[156:157], v[156:157]
    v_pk_mul_f32 v[190:191], v[158:159], v[158:159]
    v_pk_fma_f32 v[184:185], v[184:185], v[252:253], v[252:253] op_sel:[0,1,0] op_sel_hi:[1,1,0]
    v_pk_fma_f32 v[186:187], v[186:187], v[252:253], v[252:253] op_sel:[0,1,0] op_sel_hi:[1,1,0]
    v_pk_fma_f32 v[188:189], v[188:189], v[252:253], v[252:253] op_sel:[0,1,0] op_sel_hi:[1,1,0]
    v_pk_fma_f32 v[190:191], v[190:191], v[252:253], v[252:253] op_sel:[0,1,0] op_sel_hi:[1,1,0]
    v_pk_mul_f32 v[184:185], v[184:185], v[152:153]
    v_pk_mul_f32 v[186:187], v[186:187], v[154:155]
    v_pk_mul_f32 v[188:189], v[188:189], v[156:157]
    v_pk_mul_f32 v[190:191], v[190:191], v[158:159]
    v_exp_f32 v184, v184
    v_exp_f32 v185, v185
    v_exp_f32 v186, v186
    v_exp_f32 v187, v187
    v_exp_f32 v188, v188
    v_exp_f32 v189, v189
    v_exp_f32 v190, v190
    v_exp_f32 v191, v191
    v_pk_add_f32 v[184:185], v[184:185], 1.0 op_sel_hi:[1,0]
    v_pk_add_f32 v[186:187], v[186:187], 1.0 op_sel_hi:[1,0]
    v_pk_add_f32 v[188:189], v[188:189], 1.0 op_sel_hi:[1,0]
    v_pk_add_f32 v[190:191], v[190:191], 1.0 op_sel_hi:[1,0]
    v_rcp_f32 v184, v184
    v_rcp_f32 v185, v185
    v_rcp_f32 v186, v186
    v_rcp_f32 v187, v187
    v_rcp_f32 v188, v188
    v_rcp_f32 v189, v189
    v_rcp_f32 v190, v190
    v_rcp_f32 v191, v191
    v_pk_mul_f32 v[152:153], v[152:153], v[160:161]
    v_pk_mul_f32 v[154:155], v[154:155], v[162:163]
    v_pk_mul_f32 v[156:157], v[156:157], v[164:165]
    v_pk_mul_f32 v[158:159], v[158:159], v[166:167]
    v_pk_mul_f32 v[152:153], v[152:153], v[184:185]
    v_pk_mul_f32 v[154:155], v[154:155], v[186:187]
    v_pk_mul_f32 v[156:157], v[156:157], v[188:189]
    v_pk_mul_f32 v[158:159], v[158:159], v[190:191]
    v_cvt_pk_bf16_f32 v204, v152, v153
    v_cvt_pk_bf16_f32 v205, v154, v155
    v_cvt_pk_bf16_f32 v206, v156, v157
    v_cvt_pk_bf16_f32 v207, v158, v159
    buffer_store_dwordx4 v[204:207], v254, s[20:23], s3 offen offset:256 sc1
L_nogB:
    v_cvt_pk_bf16_f32 v16, v32, v33
    v_cvt_pk_bf16_f32 v17, v34, v35
    v_cvt_pk_bf16_f32 v18, v36, v37
    v_cvt_pk_bf16_f32 v19, v38, v39
    v_add_u32 v236, 0x10000, v9
    v_permlane16_swap_b32 v16, v18
    v_permlane16_swap_b32 v17, v19
    s_nop 1
    v_mfma_f32_32x32x16_bf16 v[104:119], v[20:23], v[16:19], 0
    s_barrier
    ds_read_b128 v[168:171], v8 offset:0
    ds_read_b128 v[172:175], v8 offset:2048
    s_mov_b64 exec, s[60:61]
    ds_read_b128 v[40:43], v8 offset:1024
    ds_read_b128 v[44:47], v8 offset:1280
    ds_read_b128 v[48:51], v8 offset:3072
    ds_read_b128 v[52:55], v8 offset:3328
    s_mov_b64 exec, -1
    s_add_u32 m0, s57, 0x24000
    s_add_u32 s68, s57, 0x4000
    buffer_load_dwordx4 v1, s[64:67], s68 offen sc1 lds
    s_add_u32 m0, s57, 0x26000
    s_add_u32 s68, s57, 0x6000
    buffer_load_dwordx4 v1, s[64:67], s68 offen sc1 lds
    s_mov_b32 s70, s76
    s_mul_i32 s73, s70, 458752
    s_and_b32 s69, s50, 1
    s_lshl_b32 s68, s69, 14
    s_add_u32 s73, s73, s68
    s_lshl_b32 s68, s55, 1
    s_add_u32 s68, s68, s69
    s_mul_i32 s68, s68, 112
    s_mul_i32 s69, s70, 28
    s_add_u32 s68, s68, s69
    s_lshl_b32 s68, s68, 10
    s_add_u32 s72, s68, 0x400000
    s_waitcnt lgkmcnt(0)
    v_exp_f32 v104, v104
    v_exp_f32 v105, v105
    v_exp_f32 v106, v106
    v_exp_f32 v107, v107
    v_exp_f32 v108, v108
    v_exp_f32 v109, v109
    v_mfma_f32_32x32x16_bf16 v[120:135], v[168:171], v[16:19], 0
    v_exp_f32 v110, v110
    v_exp_f32 v111, v111
    v_exp_f32 v112, v112
    v_exp_f32 v113, v113
    v_exp_f32 v114, v114
    v_exp_f32 v115, v115
    v_exp_f32 v116, v116
    v_exp_f32 v117, v117
    v_exp_f32 v118, v118
    v_exp_f32 v119, v119
    v_smfmac_f32_32x32x32_bf16 v[56:71], v[40:43], v[104:111], v28
    v_exp_f32 v120, v120
    v_exp_f32 v121, v121
    v_exp_f32 v122, v122
    v_smfmac_f32_32x32x32_bf16 v[56:71], v[52:55], v[112:119], v28
    v_exp_f32 v123, v123
    v_exp_f32 v124, v124
    v_exp_f32 v125, v125
    v_mfma_f32_32x32x16_bf16 v[104:119], v[172:175], v[16:19], 0
    v_exp_f32 v126, v126
    v_exp_f32 v127, v127
    v_exp_f32 v128, v128
    v_exp_f32 v129, v129
    v_exp_f32 v130, v130
    v_exp_f32 v131, v131
    v_exp_f32 v132, v132
    v_exp_f32 v133, v133
    v_exp_f32 v134, v134
    v_exp_f32 v135, v135
    v_smfmac_f32_32x32x32_bf16 v[56:71], v[48:51], v[120:127], v28
    s_barrier
    ds_read_b128 v[168:171], v8 offset:4096
    ds_read_b128 v[172:175], v8 offset:6144
    s_mov_b64 exec, s[60:61]
    ds_read_b128 v[40:43], v8 offset:5120
    ds_read_b128 v[44:47], v8 offset:5376
    ds_read_b128 v[48:51], v8 offset:7168
    ds_read_b128 v[52:55], v8 offset:7424
    s_mov_b64 exec, -1
    s_lshl_b32 s69, s76, 17
    s_and_b32 s70, s50, 1
    s_lshl_b32 s70, s70, 13
    s_add_u32 s69, s69, s70
    s_add_u32 m0, s57, 0x1e000
    s_add_u32 s68, s69, 0x0
    buffer_load_dwordx4 v10, s[28:31], s68 offen lds
    s_add_u32 m0, s57, 0x1c000
    s_add_u32 s68, s69, 0x8000
    buffer_load_dwordx4 v10, s[28:31], s68 offen lds
    s_waitcnt lgkmcnt(0)
    s_call_b64 s[62:63], L_YB
    s_branch L_X1B
L_YB:
    v_exp_f32 v104, v104
    v_exp_f32 v105, v105
    v_exp_f32 v106, v106
    v_smfmac_f32_32x32x32_bf16 v[56:71], v[44:47], v[128:135], v28
    v_exp_f32 v107, v107
    v_exp_f32 v108, v108
    v_exp_f32 v109, v109
    v_mfma_f32_32x32x16_bf16 v[120:135], v[168:171], v[16:19], 0
    v_exp_f32 v110, v110
    v_exp_f32 v111, v111
    v_exp_f32 v112, v112
    v_exp_f32 v113, v113
    v_exp_f32 v114, v114
    v_exp_f32 v115, v115
    v_exp_f32 v116, v116
    v_exp_f32 v117, v117
    v_exp_f32 v118, v118
    v_exp_f32 v119, v119
    v_smfmac_f32_32x32x32_bf16 v[56:71], v[40:43], v[104:111], v28
    v_exp_f32 v120, v120
    v_exp_f32 v121, v121
    v_exp_f32 v122, v122
    v_smfmac_f32_32x32x32_bf16 v[56:71], v[52:55], v[112:119], v28
    v_exp_f32 v123, v123
    v_exp_f32 v124, v124
    v_exp_f32 v125, v125
    v_mfma_f32_32x32x16_bf16 v[104:119], v[172:175], v[16:19], 0
    v_exp_f32 v126, v126
    v_exp_f32 v127, v127
    v_exp_f32 v128, v128
    v_exp_f32 v129, v129
    v_exp_f32 v130, v130
    v_exp_f32 v131, v131
    v_exp_f32 v132, v132
    v_exp_f32 v133, v133
    v_exp_f32 v134, v134
    v_exp_f32 v135, v135
    v_smfmac_f32_32x32x32_bf16 v[56:71], v[48:51], v[120:127], v28
    s_barrier
    s_setpc_b64 s[62:63]
L_X1B:
    s_waitcnt vmcnt(3)
    ds_read_b128 v[168:171], v8 offset:8192
    ds_read_b128 v[172:175], v8 offset:10240
    s_mov_b64 exec, s[60:61]
    ds_read_b128 v[40:43], v8 offset:9216
    ds_read_b128 v[44:47], v8 offset:9472
    ds_read_b128 v[48:51], v8 offset:11264
    ds_read_b128 v[52:55], v8 offset:11520
    s_mov_b64 exec, -1
    s_add_u32 m0, s57, 0x20000
    s_add_u32 s68, s57, 0x8000
    buffer_load_dwordx4 v1, s[64:67], s68 offen sc1 lds
    s_lshl_b32 s69, s76, 17
    s_and_b32 s70, s50, 1
    s_lshl_b32 s70, s70, 13
    s_add_u32 s69, s69, s70
    s_add_u32 m0, s57, 0x1a000
    s_add_u32 s68, s69, 0x10000
    buffer_load_dwordx4 v10, s[28:31], s68 offen lds
    s_add_u32 m0, s57, 0x18000
    s_add_u32 s68, s69, 0x18000
    buffer_load_dwordx4 v10, s[28:31], s68 offen lds
    s_waitcnt lgkmcnt(0)
    s_call_b64 s[62:63], L_YB
    s_cmp_ge_u32 s54, 14
    s_cbranch_scc1 L_nohf
    s_cmp_lg_u32 s50, 4
    s_cbranch_scc1 L_nohf
    s_lshl_b32 s68, s53, 4
    s_add_u32 s68, s68, s54
    s_lshl_b32 s68, s68, 7
    s_add_u32 s68, s68, 0x30000
    s_mov_b64 exec, 1
    buffer_store_dword v11, off, s[20:23], s68 sc1
    s_mov_b64 exec, -1
L_nohf:
    ds_read_b128 v[168:171], v8 offset:12288
    ds_read_b128 v[172:175], v8 offset:14336
    s_mov_b64 exec, s[60:61]
    ds_read_b128 v[40:43], v8 offset:13312
    ds_read_b128 v[44:47], v8 offset:13568
    ds_read_b128 v[48:51], v8 offset:15360
    ds_read_b128 v[52:55], v8 offset:15616
    s_mov_b64 exec, -1
    s_lshl_b32 s69, s76, 17
    s_and_b32 s70, s50, 1
    s_lshl_b32 s70, s70, 13
    s_add_u32 s69, s69, s70
    s_add_u32 m0, s57, 0x16000
    s_add_u32 s68, s69, 0x4000
    buffer_load_dwordx4 v10, s[28:31], s68 offen lds
    s_add_u32 m0, s57, 0x14000
    s_add_u32 s68, s69, 0xc000
    buffer_load_dwordx4 v10, s[28:31], s68 offen lds
    s_waitcnt lgkmcnt(0)
    s_call_b64 s[62:63], L_YB
    s_waitcnt vmcnt(7)
    ds_read_b128 v[168:171], v8 offset:16384
    ds_read_b128 v[172:175], v8 offset:18432
    s_mov_b64 exec, s[60:61]
    ds_read_b128 v[40:43], v8 offset:17408
    ds_read_b128 v[44:47], v8 offset:17664
    ds_read_b128 v[48:51], v8 offset:19456
    ds_read_b128 v[52:55], v8 offset:19712
    s_mov_b64 exec, -1
    s_add_u32 m0, s57, 0x22000
    s_add_u32 s68, s57, 0xa000
    buffer_load_dwordx4 v1, s[64:67], s68 offen sc1 lds
    s_lshl_b32 s69, s76, 17
    s_and_b32 s70, s50, 1
    s_lshl_b32 s70, s70, 13
    s_add_u32 s69, s69, s70
    s_add_u32 m0, s57, 0x12000
    s_add_u32 s68, s69, 0x14000
    buffer_load_dwordx4 v10, s[28:31], s68 offen lds
    s_add_u32 m0, s57, 0x10000
    s_add_u32 s68, s69, 0x1c000
    buffer_load_dwordx4 v10, s[28:31], s68 offen lds
    s_waitcnt lgkmcnt(0)
    s_call_b64 s[62:63], L_YB
    ds_read_b128 v[168:171], v8 offset:20480
    ds_read_b128 v[172:175], v8 offset:22528
    s_mov_b64 exec, s[60:61]
    ds_read_b128 v[40:43], v8 offset:21504
    ds_read_b128 v[44:47], v8 offset:21760
    ds_read_b128 v[48:51], v8 offset:23552
    ds_read_b128 v[52:55], v8 offset:23808
    s_mov_b64 exec, -1
    s_add_u32 m0, s57, 0x6000
    s_add_u32 s68, s73, 0x6a000
    buffer_load_dwordx4 v10, s[24:27], s68 offen lds
    s_add_u32 m0, s57, 0x8000
    s_add_u32 s68, s73, 0x5a000
    buffer_load_dwordx4 v10, s[24:27], s68 offen lds
    s_add_u32 m0, s57, 0xa000
    s_add_u32 s68, s73, 0x60000
    buffer_load_dwordx4 v10, s[24:27], s68 offen lds
    s_waitcnt lgkmcnt(0)
    s_call_b64 s[62:63], L_YB
    s_waitcnt vmcnt(3)
    ds_read_b128 v[168:171], v8 offset:24576
    ds_read_b128 v[172:175], v8 offset:26624
    s_mov_b64 exec, s[60:61]
    ds_read_b128 v[40:43], v8 offset:25600
    ds_read_b128 v[44:47], v8 offset:25856
    ds_read_b128 v[48:51], v8 offset:27648
    ds_read_b128 v[52:55], v8 offset:27904
    s_mov_b64 exec, -1
    s_add_u32 m0, s57, 0x24000
    s_add_u32 s68, s57, 0xc000
    buffer_load_dwordx4 v1, s[64:67], s68 offen sc1 lds
    s_add_u32 m0, s57, 0xc000
    s_add_u32 s68, s73, 0x62000
    buffer_load_dwordx4 v10, s[24:27], s68 offen lds
    s_add_u32 m0, s57, 0xe000
    s_add_u32 s68, s73, 0x68000
    buffer_load_dwordx4 v10, s[24:27], s68 offen lds
    s_add_u32 m0, s57, 0x0
    s_add_u32 s68, s73, 0x0
    buffer_load_dwordx4 v10, s[24:27], s68 offen lds
    s_waitcnt lgkmcnt(0)
    s_call_b64 s[62:63], L_YB
    ds_read_b128 v[168:171], v8 offset:28672
    ds_read_b128 v[172:175], v8 offset:30720
    s_mov_b64 exec, s[60:61]
    ds_read_b128 v[40:43], v8 offset:29696
    ds_read_b128 v[44:47], v8 offset:29952
    ds_read_b128 v[48:51], v8 offset:31744
    ds_read_b128 v[52:55], v8 offset:32000
    s_mov_b64 exec, -1
    s_add_u32 m0, s57, 0x2000
    s_add_u32 s68, s73, 0x2000
    buffer_load_dwordx4 v10, s[24:27], s68 offen lds
    s_add_u32 m0, s57, 0x4000
    s_add_u32 s68, s73, 0x8000
    buffer_load_dwordx4 v10, s[24:27], s68 offen lds
    ds_read_b64_tr_b16 v[32:33], v236 offset:57344
    ds_read_b64_tr_b16 v[34:35], v236 offset:58368
    ds_read_b64_tr_b16 v[36:37], v236 offset:57856
    ds_read_b64_tr_b16 v[38:39], v236 offset:58880
    ds_read_b64_tr_b16 v[208:209], v236 offset:49152
    ds_read_b64_tr_b16 v[210:211], v236 offset:50176
    ds_read_b64_tr_b16 v[212:213], v236 offset:49664
    ds_read_b64_tr_b16 v[214:215], v236 offset:50688
    s_waitcnt lgkmcnt(0)
    s_call_b64 s[62:63], L_YB
    ds_read_b128 v[168:171], v8 offset:0
    ds_read_b128 v[172:175], v8 offset:2048
    s_mov_b64 exec, s[60:61]
    ds_read_b128 v[40:43], v8 offset:1024
    ds_read_b128 v[44:47], v8 offset:1280
    ds_read_b128 v[48:51], v8 offset:3072
    ds_read_b128 v[52:55], v8 offset:3328
    s_mov_b64 exec, -1
    s_add_u32 m0, s57, 0x26000
    s_add_u32 s68, s57, 0xe000
    buffer_load_dwordx4 v1, s[64:67], s68 offen sc1 lds
    ds_read_b64_tr_b16 v[216:217], v236 offset:40960
    ds_read_b64_tr_b16 v[218:219], v236 offset:41984
    ds_read_b64_tr_b16 v[220:221], v236 offset:41472
    ds_read_b64_tr_b16 v[222:223], v236 offset:42496
    ds_read_b64_tr_b16 v[240:241], v236 offset:32768
    ds_read_b64_tr_b16 v[242:243], v236 offset:33792
    ds_read_b64_tr_b16 v[244:245], v236 offset:33280
    ds_read_b64_tr_b16 v[246:247], v236 offset:34304
    s_waitcnt lgkmcnt(0)
    s_call_b64 s[62:63], L_YB
    s_waitcnt vmcnt(9)
    ds_read_b128 v[168:171], v8 offset:4096
    ds_read_b128 v[172:175], v8 offset:6144
    s_mov_b64 exec, s[60:61]
    ds_read_b128 v[40:43], v8 offset:5120
    ds_read_b128 v[44:47], v8 offset:5376
    ds_read_b128 v[48:51], v8 offset:7168
    ds_read_b128 v[52:55], v8 offset:7424
    s_mov_b64 exec, -1
    ds_read_b64_tr_b16 v[248:249], v236 offset:24576
    ds_read_b64_tr_b16 v[250:251], v236 offset:25600
    ds_read_b64_tr_b16 v[252:253], v236 offset:25088
    ds_read_b64_tr_b16 v[254:255], v236 offset:26112
    s_add_u32 s68, s72, 0x0
    buffer_load_dwordx4 v[136:139], v1, s[20:23], s68 offen sc1
    s_waitcnt lgkmcnt(0)
    s_call_b64 s[62:63], L_YB
    s_waitcnt vmcnt(7)
    ds_read_b128 v[168:171], v8 offset:8192
    ds_read_b128 v[172:175], v8 offset:10240
    s_mov_b64 exec, s[60:61]
    ds_read_b128 v[40:43], v8 offset:9216
    ds_read_b128 v[44:47], v8 offset:9472
    ds_read_b128 v[48:51], v8 offset:11264
    ds_read_b128 v[52:55], v8 offset:11520
    s_mov_b64 exec, -1
    s_add_u32 m0, s57, 0x20000
    s_add_u32 s68, s57, 0x10000
    buffer_load_dwordx4 v1, s[64:67], s68 offen sc1 lds
    ds_read_b64_tr_b16 v[224:225], v9 offset:24576
    ds_read_b64_tr_b16 v[226:227], v9 offset:25600
    ds_read_b64_tr_b16 v[228:229], v9 offset:25088
    ds_read_b64_tr_b16 v[230:231], v9 offset:26112
    s_add_u32 s68, s72, 0x400
    buffer_load_dwordx4 v[140:143], v1, s[20:23], s68 offen sc1
    s_waitcnt lgkmcnt(0)
    s_call_b64 s[62:63], L_YB
    s_waitcnt vmcnt(6)
    ds_read_b128 v[168:171], v8 offset:12288
    ds_read_b128 v[172:175], v8 offset:14336
    s_mov_b64 exec, s[60:61]
    ds_read_b128 v[40:43], v8 offset:13312
    ds_read_b128 v[44:47], v8 offset:13568
    ds_read_b128 v[48:51], v8 offset:15360
    ds_read_b128 v[52:55], v8 offset:15616
    s_mov_b64 exec, -1
    s_add_u32 s68, s72, 0x800
    buffer_load_dwordx4 v[144:147], v1, s[20:23], s68 offen sc1
    s_add_u32 s72, s72, 0xc00
    s_add_u32 s73, s73, 0xa000
    s_add_u32 s74, s57, 0x12000
    s_mov_b32 s77, 4
    s_add_u32 s58, s79, 0x1000
    s_mov_b32 s81, 0x37800000
    s_mov_b32 s75, 0x3a000000
    s_waitcnt lgkmcnt(0)
    s_call_b64 s[62:63], L_YB
L_loopB:
    s_waitcnt vmcnt(3)
    ds_read_b128 v[168:171], v29 offset:0
    ds_read_b128 v[172:175], v29 offset:2048
    s_mov_b64 exec, s[60:61]
    ds_read_b128 v[40:43], v29 offset:1024
    ds_read_b128 v[44:47], v29 offset:1280
    ds_read_b128 v[48:51], v29 offset:3072
    ds_read_b128 v[52:55], v29 offset:3328
    s_mov_b64 exec, -1
    ds_read_b64_tr_b16 v[176:177], v9 offset:0
    ds_read_b64_tr_b16 v[178:179], v9 offset:1024
    ds_read_b64_tr_b16 v[180:181], v9 offset:512
    ds_read_b64_tr_b16 v[182:183], v9 offset:1536
    s_add_u32 m0, s57, 0x6000
    s_and_b32 s68, s74, 0x7fff
    buffer_load_dwordx4 v10, s[24:27], s73 offen lds
    s_add_u32 s73, s73, 0x6000
    buffer_load_dwordx4 v[148:151], v1, s[20:23], s72 offen sc1
    s_add_u32 m0, s68, 0x20000
    s_add_u32 s72, s72, 0x400
    buffer_load_dwordx4 v1, s[64:67], s74 offen sc1 lds
    s_add_u32 s74, s74, 0x2000
    s_waitcnt lgkmcnt(0)
    v_exp_f32 v104, v104
    v_exp_f32 v105, v105
    v_exp_f32 v106, v106
    v_smfmac_f32_32x32x32_bf16 v[56:71], v[44:47], v[128:135], v28
    v_exp_f32 v107, v107
    v_exp_f32 v108, v108
    v_exp_f32 v109, v109
    v_mfma_f32_32x32x16_bf16 v[120:135], v[168:171], v[16:19], 0
    v_exp_f32 v110, v110
    v_exp_f32 v111, v111
    v_exp_f32 v112, v112
    v_exp_f32 v113, v113
    v_exp_f32 v114, v114
    v_smfmac_f32_32x32x32_bf16 v[56:71], v[40:43], v[104:111], v28
    v_exp_f32 v115, v115
    v_exp_f32 v116, v116
    v_exp_f32 v117, v117
    v_exp_f32 v118, v118
    v_exp_f32 v119, v119
    v_mfma_f32_32x32x16_bf16 v[72:87], v[176:179], v[136:139], v[72:87]
    v_exp_f32 v120, v120
    v_exp_f32 v121, v121
    v_exp_f32 v122, v122
    v_smfmac_f32_32x32x32_bf16 v[56:71], v[52:55], v[112:119], v28
    v_exp_f32 v123, v123
    v_exp_f32 v124, v124
    v_exp_f32 v125, v125
    v_mfma_f32_32x32x16_bf16 v[104:119], v[172:175], v[16:19], 0
    v_exp_f32 v126, v126
    v_exp_f32 v127, v127
    v_exp_f32 v128, v128
    v_exp_f32 v129, v129
    v_exp_f32 v130, v130
    v_smfmac_f32_32x32x32_bf16 v[56:71], v[48:51], v[120:127], v28
    v_exp_f32 v131, v131
    v_exp_f32 v132, v132
    v_exp_f32 v133, v133
    v_exp_f32 v134, v134
    v_exp_f32 v135, v135
    v_mfma_f32_32x32x16_bf16 v[88:103], v[180:183], v[136:139], v[88:103]
    s_barrier
    s_waitcnt vmcnt(4)
    ds_read_b128 v[168:171], v29 offset:4096
    ds_read_b128 v[172:175], v29 offset:6144
    s_mov_b64 exec, s[60:61]
    ds_read_b128 v[40:43], v29 offset:5120
    ds_read_b128 v[44:47], v29 offset:5376
    ds_read_b128 v[48:51], v29 offset:7168
    ds_read_b128 v[52:55], v29 offset:7424
    s_mov_b64 exec, -1
    ds_read_b64_tr_b16 v[176:177], v9 offset:8192
    ds_read_b64_tr_b16 v[178:179], v9 offset:9216
    ds_read_b64_tr_b16 v[180:181], v9 offset:8704
    ds_read_b64_tr_b16 v[182:183], v9 offset:9728
    s_add_u32 m0, s57, 0x0
    s_and_b32 s68, s74, 0x7fff
    buffer_load_dwordx4 v10, s[24:27], s73 offen lds
    s_add_u32 s73, s73, 0x2000
    buffer_load_dwordx4 v[136:139], v1, s[20:23], s72 offen sc1
    s_add_u32 s72, s72, 0x400
    s_waitcnt lgkmcnt(0)
    v_exp_f32 v104, v104
    v_exp_f32 v105, v105
    v_exp_f32 v106, v106
    v_smfmac_f32_32x32x32_bf16 v[56:71], v[44:47], v[128:135], v28
    v_exp_f32 v107, v107
    v_exp_f32 v108, v108
    v_exp_f32 v109, v109
    v_mfma_f32_32x32x16_bf16 v[120:135], v[168:171], v[16:19], 0
    v_exp_f32 v110, v110
    v_exp_f32 v111, v111
    v_exp_f32 v112, v112
    v_exp_f32 v113, v113
    v_exp_f32 v114, v114
    v_smfmac_f32_32x32x32_bf16 v[56:71], v[40:43], v[104:111], v28
    v_exp_f32 v115, v115
    v_exp_f32 v116, v116
    v_exp_f32 v117, v117
    v_exp_f32 v118, v118
    v_exp_f32 v119, v119
    v_mfma_f32_32x32x16_bf16 v[72:87], v[176:179], v[140:143], v[72:87]
    v_exp_f32 v120, v120
    v_exp_f32 v121, v121
    v_exp_f32 v122, v122
    v_smfmac_f32_32x32x32_bf16 v[56:71], v[52:55], v[112:119], v28
    v_exp_f32 v123, v123
    v_exp_f32 v124, v124
    v_exp_f32 v125, v125
    v_mfma_f32_32x32x16_bf16 v[104:119], v[172:175], v[16:19], 0
    v_exp_f32 v126, v126
    v_exp_f32 v127, v127
    v_exp_f32 v128, v128
    v_exp_f32 v129, v129
    v_exp_f32 v130, v130
    v_smfmac_f32_32x32x32_bf16 v[56:71], v[48:51], v[120:127], v28
    v_exp_f32 v131, v131
    v_exp_f32 v132, v132
    v_exp_f32 v133, v133
    v_exp_f32 v134, v134
    v_exp_f32 v135, v135
    v_mfma_f32_32x32x16_bf16 v[88:103], v[180:183], v[140:143], v[88:103]
    s_barrier
    s_waitcnt vmcnt(4)
    ds_read_b128 v[168:171], v29 offset:8192
    ds_read_b128 v[172:175], v29 offset:10240
    s_mov_b64 exec, s[60:61]
    ds_read_b128 v[40:43], v29 offset:9216
    ds_read_b128 v[44:47], v29 offset:9472
    ds_read_b128 v[48:51], v29 offset:11264
    ds_read_b128 v[52:55], v29 offset:11520
    s_mov_b64 exec, -1
    ds_read_b64_tr_b16 v[176:177], v9 offset:16384
    ds_read_b64_tr_b16 v[178:179], v9 offset:17408
    ds_read_b64_tr_b16 v[180:181], v9 offset:16896
    ds_read_b64_tr_b16 v[182:183], v9 offset:17920
    s_add_u32 m0, s57, 0x2000
    s_and_b32 s68, s74, 0x7fff
    buffer_load_dwordx4 v10, s[24:27], s73 offen lds
    s_add_u32 s73, s73, 0x6000
    buffer_load_dwordx4 v[140:143], v1, s[20:23], s72 offen sc1
    s_add_u32 m0, s68, 0x20000
    s_add_u32 s72, s72, 0x400
    buffer_load_dwordx4 v1, s[64:67], s74 offen sc1 lds
    s_add_u32 s74, s74, 0x2000
    s_waitcnt lgkmcnt(0)
    v_exp_f32 v104, v104
    v_exp_f32 v105, v105
    v_exp_f32 v106, v106
    v_smfmac_f32_32x32x32_bf16 v[56:71], v[44:47], v[128:135], v28
    v_exp_f32 v107, v107
    v_exp_f32 v108, v108
    v_exp_f32 v109, v109
    v_mfma_f32_32x32x16_bf16 v[120:135], v[168:171], v[16:19], 0
    v_exp_f32 v110, v110
    v_exp_f32 v111, v111
    v_exp_f32 v112, v112
    v_exp_f32 v113, v113
    v_exp_f32 v114, v114
    v_smfmac_f32_32x32x32_bf16 v[56:71], v[40:43], v[104:111], v28
    v_exp_f32 v115, v115
    v_exp_f32 v116, v116
    v_exp_f32 v117, v117
    v_exp_f32 v118, v118
    v_exp_f32 v119, v119
    v_mfma_f32_32x32x16_bf16 v[72:87], v[176:179], v[144:147], v[72:87]
    v_exp_f32 v120, v120
    v_exp_f32 v121, v121
    v_exp_f32 v122, v122
    v_smfmac_f32_32x32x32_bf16 v[56:71], v[52:55], v[112:119], v28
    v_exp_f32 v123, v123
    v_exp_f32 v124, v124
    v_exp_f32 v125, v125
    v_mfma_f32_32x32x16_bf16 v[104:119], v[172:175], v[16:19], 0
    v_exp_f32 v126, v126
    v_exp_f32 v127, v127
    v_exp_f32 v128, v128
    v_exp_f32 v129, v129
    v_exp_f32 v130, v130
    v_smfmac_f32_32x32x32_bf16 v[56:71], v[48:51], v[120:127], v28
    v_exp_f32 v131, v131
    v_exp_f32 v132, v132
    v_exp_f32 v133, v133
    v_exp_f32 v134, v134
    v_exp_f32 v135, v135
    v_mfma_f32_32x32x16_bf16 v[88:103], v[180:183], v[144:147], v[88:103]
    s_barrier
    s_waitcnt vmcnt(4)
    ds_read_b128 v[168:171], v29 offset:12288
    ds_read_b128 v[172:175], v29 offset:14336
    s_mov_b64 exec, s[60:61]
    ds_read_b128 v[40:43], v29 offset:13312
    ds_read_b128 v[44:47], v29 offset:13568
    ds_read_b128 v[48:51], v29 offset:15360
    ds_read_b128 v[52:55], v29 offset:15616
    s_mov_b64 exec, -1
    ds_read_b64_tr_b16 v[176:177], v9 offset:24576
    ds_read_b64_tr_b16 v[178:179], v9 offset:25600
    ds_read_b64_tr_b16 v[180:181], v9 offset:25088
    ds_read_b64_tr_b16 v[182:183], v9 offset:26112
    s_add_u32 m0, s57, 0x4000
    s_and_b32 s68, s74, 0x7fff
    buffer_load_dwordx4 v10, s[24:27], s73 offen lds
    s_add_u32 s73, s73, 0x2000
    buffer_load_dwordx4 v[144:147], v1, s[20:23], s72 offen sc1
    s_add_u32 s72, s72, 0x400
    s_sub_u32 s77, s77, 1
    s_cmp_lg_u32 s77, 0
    s_waitcnt lgkmcnt(0)
    v_exp_f32 v104, v104
    v_exp_f32 v105, v105
    v_exp_f32 v106, v106
    v_smfmac_f32_32x32x32_bf16 v[56:71], v[44:47], v[128:135], v28
    v_exp_f32 v107, v107
    v_exp_f32 v108, v108
    v_exp_f32 v109, v109
    v_mfma_f32_32x32x16_bf16 v[120:135], v[168:171], v[16:19], 0
    v_exp_f32 v110, v110
    v_exp_f32 v111, v111
    v_exp_f32 v112, v112
    v_exp_f32 v113, v113
    v_exp_f32 v114, v114
    v_smfmac_f32_32x32x32_bf16 v[56:71], v[40:43], v[104:111], v28
    v_exp_f32 v115, v115
    v_exp_f32 v116, v116
    v_exp_f32 v117, v117
    v_exp_f32 v118, v118
    v_exp_f32 v119, v119
    v_mfma_f32_32x32x16_bf16 v[72:87], v[176:179], v[148:151], v[72:87]
    v_exp_f32 v120, v120
    v_exp_f32 v121, v121
    v_exp_f32 v122, v122
    v_smfmac_f32_32x32x32_bf16 v[56:71], v[52:55], v[112:119], v28
    v_exp_f32 v123, v123
    v_exp_f32 v124, v124
    v_exp_f32 v125, v125
    v_mfma_f32_32x32x16_bf16 v[104:119], v[172:175], v[16:19], 0
    v_exp_f32 v126, v126
    v_exp_f32 v127, v127
    v_exp_f32 v128, v128
    v_exp_f32 v129, v129
    v_exp_f32 v130, v130
    v_smfmac_f32_32x32x32_bf16 v[56:71], v[48:51], v[120:127], v28
    v_exp_f32 v131, v131
    v_exp_f32 v132, v132
    v_xor_b32 v29, 0x4000, v29
    v_exp_f32 v133, v133
    v_exp_f32 v134, v134
    v_exp_f32 v135, v135
    v_mfma_f32_32x32x16_bf16 v[88:103], v[180:183], v[148:151], v[88:103]
    s_barrier
    s_cbranch_scc1 L_loopB
    s_waitcnt vmcnt(4)
    ds_read_b128 v[168:171], v29 offset:0
    ds_read_b128 v[172:175], v29 offset:2048
    s_mov_b64 exec, s[60:61]
    ds_read_b128 v[40:43], v29 offset:1024
    ds_read_b128 v[44:47], v29 offset:1280
    ds_read_b128 v[48:51], v29 offset:3072
    ds_read_b128 v[52:55], v29 offset:3328
    s_mov_b64 exec, -1
    ds_read_b64_tr_b16 v[176:177], v9 offset:0
    ds_read_b64_tr_b16 v[178:179], v9 offset:1024
    ds_read_b64_tr_b16 v[180:181], v9 offset:512
    ds_read_b64_tr_b16 v[182:183], v9 offset:1536
    s_add_u32 m0, s57, 0x6000
    s_and_b32 s68, s74, 0x7fff
    buffer_load_dwordx4 v10, s[24:27], s73 offen lds
    s_add_u32 s73, s73, 0x6000
    buffer_load_dwordx4 v[148:151], v1, s[20:23], s72 offen sc1
    s_add_u32 s72, s72, 0x400
    s_add_u32 s68, s72, 0x1c00
    buffer_load_dwordx4 v[232:235], v1, s[20:23], s68 offen sc1
    s_add_u32 s68, s72, 0xc00
    buffer_load_dwordx4 v[152:155], v1, s[20:23], s68 offen sc1
    s_waitcnt lgkmcnt(0)
    v_exp_f32 v104, v104
    v_exp_f32 v105, v105
    v_exp_f32 v106, v106
    v_smfmac_f32_32x32x32_bf16 v[56:71], v[44:47], v[128:135], v28
    v_exp_f32 v107, v107
    v_exp_f32 v108, v108
    v_exp_f32 v109, v109
    v_mfma_f32_32x32x16_bf16 v[120:135], v[168:171], v[16:19], 0
    v_exp_f32 v110, v110
    v_exp_f32 v111, v111
    v_exp_f32 v112, v112
    v_exp_f32 v113, v113
    v_exp_f32 v114, v114
    v_smfmac_f32_32x32x32_bf16 v[56:71], v[40:43], v[104:111], v28
    v_exp_f32 v115, v115
    v_exp_f32 v116, v116
    v_exp_f32 v117, v117
    v_exp_f32 v118, v118
    v_exp_f32 v119, v119
    v_mfma_f32_32x32x16_bf16 v[72:87], v[176:179], v[136:139], v[72:87]
    v_exp_f32 v120, v120
    v_exp_f32 v121, v121
    v_exp_f32 v122, v122
    v_smfmac_f32_32x32x32_bf16 v[56:71], v[52:55], v[112:119], v28
    v_exp_f32 v123, v123
    v_exp_f32 v124, v124
    v_exp_f32 v125, v125
    v_mfma_f32_32x32x16_bf16 v[104:119], v[172:175], v[16:19], 0
    v_exp_f32 v126, v126
    v_exp_f32 v127, v127
    v_exp_f32 v128, v128
    v_exp_f32 v129, v129
    v_exp_f32 v130, v130
    v_smfmac_f32_32x32x32_bf16 v[56:71], v[48:51], v[120:127], v28
    v_exp_f32 v131, v131
    v_exp_f32 v132, v132
    v_exp_f32 v133, v133
    v_exp_f32 v134, v134
    v_exp_f32 v135, v135
    v_mfma_f32_32x32x16_bf16 v[88:103], v[180:183], v[136:139], v[88:103]
    s_barrier
    s_waitcnt vmcnt(5)
    ds_read_b128 v[168:171], v29 offset:4096
    ds_read_b128 v[172:175], v29 offset:6144
    s_mov_b64 exec, s[60:61]
    ds_read_b128 v[40:43], v29 offset:5120
    ds_read_b128 v[44:47], v29 offset:5376
    ds_read_b128 v[48:51], v29 offset:7168
    ds_read_b128 v[52:55], v29 offset:7424
    s_mov_b64 exec, -1
    ds_read_b64_tr_b16 v[176:177], v9 offset:8192
    ds_read_b64_tr_b16 v[178:179], v9 offset:9216
    ds_read_b64_tr_b16 v[180:181], v9 offset:8704
    ds_read_b64_tr_b16 v[182:183], v9 offset:9728
    s_add_u32 m0, s57, 0x0
    s_and_b32 s68, s74, 0x7fff
    buffer_load_dwordx4 v10, s[24:27], s73 offen lds
    s_add_u32 s73, s73, 0x2000
    buffer_load_dwordx4 v[136:139], v1, s[20:23], s72 offen sc1
    s_add_u32 s72, s72, 0x400
    s_add_u32 s68, s72, 0xc00
    buffer_load_dwordx4 v[156:159], v1, s[20:23], s68 offen sc1
    s_add_u32 s68, s72, 0x1000
    buffer_load_dwordx4 v[160:163], v1, s[20:23], s68 offen sc1
    s_waitcnt lgkmcnt(0)
    v_exp_f32 v104, v104
    v_exp_f32 v105, v105
    v_exp_f32 v106, v106
    v_smfmac_f32_32x32x32_bf16 v[56:71], v[44:47], v[128:135], v28
    v_exp_f32 v107, v107
    v_exp_f32 v108, v108
    v_exp_f32 v109, v109
    v_mfma_f32_32x32x16_bf16 v[120:135], v[168:171], v[16:19], 0
    v_exp_f32 v110, v110
    v_exp_f32 v111, v111
    v_exp_f32 v112, v112
    v_exp_f32 v113, v113
    v_exp_f32 v114, v114
    v_smfmac_f32_32x32x32_bf16 v[56:71], v[40:43], v[104:111], v28
    v_exp_f32 v115, v115
    v_exp_f32 v116, v116
    v_exp_f32 v117, v117
    v_exp_f32 v118, v118
    v_exp_f32 v119, v119
    v_mfma_f32_32x32x16_bf16 v[72:87], v[176:179], v[140:143], v[72:87]
    v_exp_f32 v120, v120
    v_exp_f32 v121, v121
    v_exp_f32 v122, v122
    v_smfmac_f32_32x32x32_bf16 v[56:71], v[52:55], v[112:119], v28
    v_exp_f32 v123, v123
    v_exp_f32 v124, v124
    v_exp_f32 v125, v125
    v_mfma_f32_32x32x16_bf16 v[104:119], v[172:175], v[16:19], 0
    v_exp_f32 v126, v126
    v_exp_f32 v127, v127
    v_exp_f32 v128, v128
    v_exp_f32 v129, v129
    v_exp_f32 v130, v130
    v_smfmac_f32_32x32x32_bf16 v[56:71], v[48:51], v[120:127], v28
    v_exp_f32 v131, v131
    v_exp_f32 v132, v132
    v_exp_f32 v133, v133
    v_exp_f32 v134, v134
    v_exp_f32 v135, v135
    v_mfma_f32_32x32x16_bf16 v[88:103], v[180:183], v[140:143], v[88:103]
    s_barrier
    s_waitcnt vmcnt(7)
    ds_read_b128 v[168:171], v29 offset:8192
    ds_read_b128 v[172:175], v29 offset:10240
    s_mov_b64 exec, s[60:61]
    ds_read_b128 v[40:43], v29 offset:9216
    ds_read_b128 v[44:47], v29 offset:9472
    ds_read_b128 v[48:51], v29 offset:11264
    ds_read_b128 v[52:55], v29 offset:11520
    s_mov_b64 exec, -1
    ds_read_b64_tr_b16 v[176:177], v9 offset:16384
    ds_read_b64_tr_b16 v[178:179], v9 offset:17408
    ds_read_b64_tr_b16 v[180:181], v9 offset:16896
    ds_read_b64_tr_b16 v[182:183], v9 offset:17920
    s_add_u32 m0, s57, 0x2000
    s_and_b32 s68, s74, 0x7fff
    buffer_load_dwordx4 v10, s[24:27], s73 offen lds
    s_add_u32 s73, s73, 0x6000
    buffer_load_dwordx4 v[140:143], v1, s[20:23], s72 offen sc1
    s_add_u32 s72, s72, 0x400
    s_add_u32 s68, s72, 0x1000
    buffer_load_dwordx4 v[164:167], v1, s[20:23], s68 offen sc1
    s_waitcnt lgkmcnt(0)
    v_exp_f32 v104, v104
    v_exp_f32 v105, v105
    v_exp_f32 v106, v106
    v_smfmac_f32_32x32x32_bf16 v[56:71], v[44:47], v[128:135], v28
    v_exp_f32 v107, v107
    v_exp_f32 v108, v108
    v_exp_f32 v109, v109
    v_mfma_f32_32x32x16_bf16 v[120:135], v[168:171], v[16:19], 0
    v_exp_f32 v110, v110
    v_exp_f32 v111, v111
    v_exp_f32 v112, v112
    v_exp_f32 v113, v113
    v_exp_f32 v114, v114
    v_smfmac_f32_32x32x32_bf16 v[56:71], v[40:43], v[104:111], v28
    v_exp_f32 v115, v115
    v_exp_f32 v116, v116
    v_exp_f32 v117, v117
    v_exp_f32 v118, v118
    v_exp_f32 v119, v119
    v_mfma_f32_32x32x16_bf16 v[72:87], v[176:179], v[144:147], v[72:87]
    v_exp_f32 v120, v120
    v_exp_f32 v121, v121
    v_exp_f32 v122, v122
    v_smfmac_f32_32x32x32_bf16 v[56:71], v[52:55], v[112:119], v28
    v_exp_f32 v123, v123
    v_exp_f32 v124, v124
    v_exp_f32 v125, v125
    v_mfma_f32_32x32x16_bf16 v[104:119], v[172:175], v[16:19], 0
    v_exp_f32 v126, v126
    v_exp_f32 v127, v127
    v_exp_f32 v128, v128
    v_exp_f32 v129, v129
    v_exp_f32 v130, v130
    v_smfmac_f32_32x32x32_bf16 v[56:71], v[48:51], v[120:127], v28
    v_exp_f32 v131, v131
    v_exp_f32 v132, v132
    v_exp_f32 v133, v133
    v_exp_f32 v134, v134
    v_exp_f32 v135, v135
    v_mfma_f32_32x32x16_bf16 v[88:103], v[180:183], v[144:147], v[88:103]
    s_barrier
    s_waitcnt vmcnt(6)
    ds_read_b128 v[168:171], v29 offset:12288
    s_mov_b64 exec, s[60:61]
    ds_read_b128 v[40:43], v29 offset:13312
    ds_read_b128 v[44:47], v29 offset:13568
    ds_read_b128 v[48:51], v29 offset:15360
    ds_read_b128 v[52:55], v29 offset:15616
    s_mov_b64 exec, -1
    ds_read_b64_tr_b16 v[176:177], v9 offset:24576
    ds_read_b64_tr_b16 v[178:179], v9 offset:25600
    ds_read_b64_tr_b16 v[180:181], v9 offset:25088
    ds_read_b64_tr_b16 v[182:183], v9 offset:26112
    ds_read_b64_tr_b16 v[184:185], v9 offset:32768
    ds_read_b64_tr_b16 v[186:187], v9 offset:33792
    ds_read_b64_tr_b16 v[188:189], v9 offset:33280
    ds_read_b64_tr_b16 v[190:191], v9 offset:34304
    s_add_u32 m0, s57, 0x4000
    s_and_b32 s68, s74, 0x7fff
    buffer_load_dwordx4 v10, s[24:27], s73 offen lds
    s_add_u32 s73, s73, 0x2000
    buffer_load_dwordx4 v[144:147], v1, s[20:23], s72 offen sc1
    s_add_u32 s72, s72, 0x400
    s_waitcnt lgkmcnt(0)
    v_exp_f32 v104, v104
    v_exp_f32 v105, v105
    v_exp_f32 v106, v106
    v_smfmac_f32_32x32x32_bf16 v[56:71], v[44:47], v[128:135], v28
    v_exp_f32 v107, v107
    v_exp_f32 v108, v108
    v_exp_f32 v109, v109
    v_mfma_f32_32x32x16_bf16 v[120:135], v[168:171], v[16:19], 0
    v_exp_f32 v110, v110
    v_exp_f32 v111, v111
    v_exp_f32 v112, v112
    v_exp_f32 v113, v113
    v_exp_f32 v114, v114
    v_exp_f32 v115, v115
    v_exp_f32 v116, v116
    v_exp_f32 v117, v117
    v_exp_f32 v118, v118
    v_exp_f32 v119, v119
    v_smfmac_f32_32x32x32_bf16 v[56:71], v[40:43], v[104:111], v28
    v_exp_f32 v120, v120
    v_exp_f32 v121, v121
    v_exp_f32 v122, v122
    v_smfmac_f32_32x32x32_bf16 v[56:71], v[52:55], v[112:119], v28
    v_exp_f32 v123, v123
    v_exp_f32 v124, v124
    v_exp_f32 v125, v125
    v_exp_f32 v126, v126
    v_exp_f32 v127, v127
    v_exp_f32 v128, v128
    v_exp_f32 v129, v129
    v_exp_f32 v130, v130
    v_smfmac_f32_32x32x32_bf16 v[56:71], v[48:51], v[120:127], v28
    v_exp_f32 v131, v131
    v_exp_f32 v132, v132
    v_exp_f32 v133, v133
    v_exp_f32 v134, v134
    v_exp_f32 v135, v135
    s_nop 1
L_tail:
    v_smfmac_f32_32x32x32_bf16 v[56:71], v[24:27], v[128:135], v28
    s_cmp_eq_u32 s51, 0
    s_nop 10
.p2align 3
    v_rcp_f32 v4, v64
    s_nop 0
    v_mul_f32_e64 v4, v4, v6
    v_pk_mul_f32 v[56:57], v[56:57], v[4:5] op_sel_hi:[1,0]
    v_pk_mul_f32 v[58:59], v[58:59], v[4:5] op_sel_hi:[1,0]
    v_pk_mul_f32 v[60:61], v[60:61], v[4:5] op_sel_hi:[1,0]
    v_pk_mul_f32 v[62:63], v[62:63], v[4:5] op_sel_hi:[1,0]
    v_pk_fma_f32 v[2:3], v[56:57], 0, v[64:65] op_sel_hi:[1,0,0]
    v_cvt_pk_bf16_f32 v20, v56, v57
    v_pk_fma_f32 v[2:3], v[58:59], 0, v[2:3] op_sel_hi:[1,0,1]
    v_cvt_pk_bf16_f32 v21, v58, v59
    v_pk_fma_f32 v[2:3], v[60:61], 0, v[2:3] op_sel_hi:[1,0,1]
    v_cvt_pk_bf16_f32 v22, v60, v61
    v_pk_fma_f32 v[2:3], v[62:63], 0, v[2:3] op_sel_hi:[1,0,1]
    v_cvt_pk_bf16_f32 v23, v62, v63
    v_fmac_f32 v2, 0, v3
    v_subrev_u32 v2, s81, v2
    v_cmp_lt_u32 vcc, s75, v2
    s_cbranch_vccnz L_fb
L_fbret:
    buffer_store_dwordx4 v[20:23], v1, s[20:23], s78 offen sc1
    s_waitcnt vmcnt(1)
    s_barrier
L_tl2:
    v_mfma_f32_32x32x16_bf16 v[72:87], v[224:227], v[232:235], v[72:87]
    v_mfma_f32_32x32x16_bf16 v[88:103], v[228:231], v[232:235], v[88:103]
    v_mfma_f32_32x32x16_bf16 v[72:87], v[176:179], v[148:151], v[72:87]
    ds_read_b64_tr_b16 v[192:193], v9 offset:40960
    ds_read_b64_tr_b16 v[194:195], v9 offset:41984
    v_mfma_f32_32x32x16_bf16 v[88:103], v[180:183], v[148:151], v[88:103]
    ds_read_b64_tr_b16 v[196:197], v9 offset:41472
    ds_read_b64_tr_b16 v[198:199], v9 offset:42496
    v_mfma_f32_32x32x16_bf16 v[72:87], v[184:187], v[152:155], v[72:87]
    ds_read_b64_tr_b16 v[200:201], v9 offset:49152
    ds_read_b64_tr_b16 v[202:203], v9 offset:50176
    v_mfma_f32_32x32x16_bf16 v[88:103], v[188:191], v[152:155], v[88:103]
    ds_read_b64_tr_b16 v[204:205], v9 offset:49664
    ds_read_b64_tr_b16 v[206:207], v9 offset:50688
    s_waitcnt lgkmcnt(6)
    v_mfma_f32_32x32x16_bf16 v[72:87], v[192:195], v[156:159], v[72:87]
    ds_read_b64_tr_b16 v[184:185], v9 offset:57344
    ds_read_b64_tr_b16 v[186:187], v9 offset:58368
    s_waitcnt lgkmcnt(6)
    v_mfma_f32_32x32x16_bf16 v[88:103], v[196:199], v[156:159], v[88:103]
    ds_read_b64_tr_b16 v[188:189], v9 offset:57856
    ds_read_b64_tr_b16 v[190:191], v9 offset:58880
    s_waitcnt lgkmcnt(6)
    v_mfma_f32_32x32x16_bf16 v[72:87], v[200:203], v[160:163], v[72:87]
    ds_read_b64_tr_b16 v[192:193], v9 offset:0
    ds_read_b64_tr_b16 v[194:195], v9 offset:1024
    s_waitcnt lgkmcnt(6)
    v_mfma_f32_32x32x16_bf16 v[88:103], v[204:207], v[160:163], v[88:103]
    ds_read_b64_tr_b16 v[196:197], v9 offset:512
    ds_read_b64_tr_b16 v[198:199], v9 offset:1536
    s_waitcnt lgkmcnt(6)
    v_mfma_f32_32x32x16_bf16 v[72:87], v[184:187], v[164:167], v[72:87]
    ds_read_b64_tr_b16 v[200:201], v9 offset:8192
    ds_read_b64_tr_b16 v[202:203], v9 offset:9216
    s_waitcnt lgkmcnt(6)
    v_mfma_f32_32x32x16_bf16 v[88:103], v[188:191], v[164:167], v[88:103]
    ds_read_b64_tr_b16 v[204:205], v9 offset:8704
    ds_read_b64_tr_b16 v[206:207], v9 offset:9728
    s_waitcnt lgkmcnt(6)
    v_mfma_f32_32x32x16_bf16 v[72:87], v[192:195], v[136:139], v[72:87]
    ds_read_b64_tr_b16 v[184:185], v9 offset:16384
    ds_read_b64_tr_b16 v[186:187], v9 offset:17408
    s_waitcnt lgkmcnt(6)
    v_mfma_f32_32x32x16_bf16 v[88:103], v[196:199], v[136:139], v[88:103]
    ds_read_b64_tr_b16 v[188:189], v9 offset:16896
    ds_read_b64_tr_b16 v[190:191], v9 offset:17920
    s_waitcnt lgkmcnt(6)
    v_mfma_f32_32x32x16_bf16 v[72:87], v[200:203], v[140:143], v[72:87]
    v_sub_f32 v7, 1.0, v7
    v_xor_b32 v237, 32, v30
    s_waitcnt lgkmcnt(4)
    v_mfma_f32_32x32x16_bf16 v[88:103], v[204:207], v[140:143], v[88:103]
    v_xor_b32 v238, 64, v30
    v_xor_b32 v239, 96, v30
    s_waitcnt lgkmcnt(2)
    v_mfma_f32_32x32x16_bf16 v[72:87], v[184:187], v[144:147], v[72:87]
    v_xor_b32 v13, 16, v31
    s_mov_b32 s69, 0x2000
    s_waitcnt lgkmcnt(0)
    v_mfma_f32_32x32x16_bf16 v[88:103], v[188:191], v[144:147], v[88:103]
    s_cbranch_scc0 L_tl3
.p2align 3
    s_nop 7
    s_nop 0
    v_pk_mul_f32 v[72:73], v[72:73], v[6:7] op_sel:[0,1] op_sel_hi:[1,1]
    v_pk_mul_f32 v[74:75], v[74:75], v[6:7] op_sel:[0,1] op_sel_hi:[1,1]
    v_pk_mul_f32 v[76:77], v[76:77], v[6:7] op_sel:[0,1] op_sel_hi:[1,1]
    v_pk_mul_f32 v[78:79], v[78:79], v[6:7] op_sel:[0,1] op_sel_hi:[1,1]
    v_pk_mul_f32 v[80:81], v[80:81], v[6:7] op_sel:[0,1] op_sel_hi:[1,1]
    v_pk_mul_f32 v[82:83], v[82:83], v[6:7] op_sel:[0,1] op_sel_hi:[1,1]
    v_pk_mul_f32 v[84:85], v[84:85], v[6:7] op_sel:[0,1] op_sel_hi:[1,1]
    v_pk_mul_f32 v[86:87], v[86:87], v[6:7] op_sel:[0,1] op_sel_hi:[1,1]
    v_pk_mul_f32 v[88:89], v[88:89], v[6:7] op_sel:[0,1] op_sel_hi:[1,1]
    v_pk_mul_f32 v[90:91], v[90:91], v[6:7] op_sel:[0,1] op_sel_hi:[1,1]
    v_pk_mul_f32 v[92:93], v[92:93], v[6:7] op_sel:[0,1] op_sel_hi:[1,1]
    v_pk_mul_f32 v[94:95], v[94:95], v[6:7] op_sel:[0,1] op_sel_hi:[1,1]
    v_pk_mul_f32 v[96:97], v[96:97], v[6:7] op_sel:[0,1] op_sel_hi:[1,1]
    v_pk_mul_f32 v[98:99], v[98:99], v[6:7] op_sel:[0,1] op_sel_hi:[1,1]
    v_pk_mul_f32 v[100:101], v[100:101], v[6:7] op_sel:[0,1] op_sel_hi:[1,1]
    v_pk_mul_f32 v[102:103], v[102:103], v[6:7] op_sel:[0,1] op_sel_hi:[1,1]
L_tl4:
    s_waitcnt vmcnt(7)
    v_max3_u32 v2, v104, v105, v106
    v_max_u32 v2, v2, v107
    v_cmp_eq_u32 vcc, -1, v2
    s_cbranch_vccnz L_ore0
L_ook0:
    v_mfma_f32_32x32x16_bf16 v[72:87], v[32:35], v[104:107], v[72:87]
    s_waitcnt vmcnt(6)
    v_max3_u32 v2, v108, v109, v110
    v_max_u32 v2, v2, v111
    v_cmp_eq_u32 vcc, -1, v2
    s_cbranch_vccnz L_ore1
L_ook1:
    v_mfma_f32_32x32x16_bf16 v[72:87], v[208:211], v[108:111], v[72:87]
    s_waitcnt vmcnt(5)
    v_max3_u32 v2, v112, v113, v114
    v_max_u32 v2, v2, v115
    v_cmp_eq_u32 vcc, -1, v2
    s_cbranch_vccnz L_ore2
L_ook2:
    v_mfma_f32_32x32x16_bf16 v[72:87], v[216:219], v[112:115], v[72:87]
    s_waitcnt vmcnt(4)
    v_max3_u32 v2, v116, v117, v118
    v_max_u32 v2, v2, v119
    v_cmp_eq_u32 vcc, -1, v2
    v_mfma_f32_32x32x16_bf16 v[88:103], v[36:39], v[104:107], v[88:103]
    s_cbranch_vccnz L_ore3
L_ook3:
    v_mfma_f32_32x32x16_bf16 v[72:87], v[240:243], v[116:119], v[72:87]
    s_waitcnt vmcnt(3)
    v_max3_u32 v2, v120, v121, v122
    v_max_u32 v2, v2, v123
    v_cmp_eq_u32 vcc, -1, v2
    v_mfma_f32_32x32x16_bf16 v[88:103], v[212:215], v[108:111], v[88:103]
    s_cbranch_vccnz L_ore4
L_ook4:
    v_mfma_f32_32x32x16_bf16 v[72:87], v[248:251], v[120:123], v[72:87]
    s_waitcnt vmcnt(2)
    v_max3_u32 v2, v124, v125, v126
    v_max_u32 v2, v2, v127
    v_cmp_eq_u32 vcc, -1, v2
    v_mfma_f32_32x32x16_bf16 v[88:103], v[220:223], v[112:115], v[88:103]
    s_cbranch_vccnz L_ore5
L_ook5:
    v_mfma_f32_32x32x16_bf16 v[72:87], v[40:43], v[124:127], v[72:87]
    s_waitcnt vmcnt(1)
    v_max3_u32 v2, v128, v129, v130
    v_max_u32 v2, v2, v131
    v_cmp_eq_u32 vcc, -1, v2
    v_mfma_f32_32x32x16_bf16 v[88:103], v[244:247], v[116:119], v[88:103]
    s_cbranch_vccnz L_ore6
L_ook6:
    v_mfma_f32_32x32x16_bf16 v[72:87], v[48:51], v[128:131], v[72:87]
    s_waitcnt vmcnt(0)
    v_max3_u32 v2, v132, v133, v134
    v_max_u32 v2, v2, v135
    v_cmp_eq_u32 vcc, -1, v2
    v_mfma_f32_32x32x16_bf16 v[88:103], v[252:255], v[120:123], v[88:103]
    s_cbranch_vccnz L_ore7
L_ook7:
    v_mfma_f32_32x32x16_bf16 v[72:87], v[56:59], v[132:135], v[72:87]
    v_mfma_f32_32x32x16_bf16 v[88:103], v[44:47], v[124:127], v[88:103]
    s_nop 4
    v_mfma_f32_32x32x16_bf16 v[88:103], v[52:55], v[128:131], v[88:103]
    s_nop 4
    v_mfma_f32_32x32x16_bf16 v[88:103], v[60:63], v[132:135], v[88:103]
    ds_write_b128 v30, v[72:75] offset:0
    ds_write_b128 v237, v[76:79] offset:0
    ds_write_b128 v238, v[80:83] offset:0
    ds_write_b128 v239, v[84:87] offset:0
    s_nop 7
    ds_write_b128 v30, v[88:91] offset:128
    ds_write_b128 v237, v[92:95] offset:128
    ds_write_b128 v238, v[96:99] offset:128
    ds_write_b128 v239, v[100:103] offset:128
    s_waitcnt lgkmcnt(0)
    s_barrier
    ds_read_b128 v[104:107], v31 offset:0
    ds_read_b128 v[108:111], v13 offset:0
    ds_read_b128 v[112:115], v31 offset:8192
    ds_read_b128 v[116:119], v13 offset:8192
    ds_read_b128 v[120:123], v31 offset:16384
    ds_read_b128 v[124:127], v13 offset:16384
    ds_read_b128 v[128:131], v31 offset:24576
    ds_read_b128 v[132:135], v13 offset:24576
    s_waitcnt lgkmcnt(4)
    v_pk_add_f32 v[104:105], v[104:105], v[112:113]
    v_pk_add_f32 v[106:107], v[106:107], v[114:115]
    v_pk_add_f32 v[108:109], v[108:109], v[116:117]
    v_pk_add_f32 v[110:111], v[110:111], v[118:119]
    s_waitcnt lgkmcnt(2)
    v_pk_add_f32 v[104:105], v[104:105], v[120:121]
    v_pk_add_f32 v[106:107], v[106:107], v[122:123]
    v_pk_add_f32 v[108:109], v[108:109], v[124:125]
    v_pk_add_f32 v[110:111], v[110:111], v[126:127]
    s_waitcnt lgkmcnt(0)
    v_pk_add_f32 v[104:105], v[104:105], v[128:129]
    v_pk_add_f32 v[106:107], v[106:107], v[130:131]
    v_pk_add_f32 v[108:109], v[108:109], v[132:133]
    v_pk_add_f32 v[110:111], v[110:111], v[134:135]
    v_cvt_pk_bf16_f32 v32, v104, v105
    v_cvt_pk_bf16_f32 v33, v106, v107
    v_cvt_pk_bf16_f32 v34, v108, v109
    v_cvt_pk_bf16_f32 v35, v110, v111
    buffer_store_dwordx4 v[32:35], v12, s[32:35], s59 offen sc0 sc1
L_end:
    s_endpgm
L_tl3:
    s_setprio 0
    buffer_load_dwordx4 v[104:107], v1, s[20:23], s79 offen offset:0 sc1
    buffer_load_dwordx4 v[108:111], v1, s[20:23], s79 offen offset:2048 sc1
    buffer_load_dwordx4 v[112:115], v1, s[20:23], s58 offen offset:0 sc1
    buffer_load_dwordx4 v[116:119], v1, s[20:23], s58 offen offset:2048 sc1
    buffer_load_dwordx4 v[120:123], v1, s[20:23], s79 offen offset:1024 sc1
    buffer_load_dwordx4 v[124:127], v1, s[20:23], s79 offen offset:3072 sc1
    ds_read_b64_tr_b16 v[40:41], v236 offset:16384
    ds_read_b64_tr_b16 v[42:43], v236 offset:17408
    ds_read_b64_tr_b16 v[44:45], v236 offset:16896
    ds_read_b64_tr_b16 v[46:47], v236 offset:17920
    buffer_load_dwordx4 v[128:131], v1, s[20:23], s58 offen offset:1024 sc1
    ds_read_b64_tr_b16 v[48:49], v236 offset:8192
    ds_read_b64_tr_b16 v[50:51], v236 offset:9216
    ds_read_b64_tr_b16 v[52:53], v236 offset:8704
    ds_read_b64_tr_b16 v[54:55], v236 offset:9728
    buffer_load_dwordx4 v[132:135], v1, s[20:23], s58 offen offset:3072 sc1
    ds_read_b64_tr_b16 v[56:57], v236 offset:0
    ds_read_b64_tr_b16 v[58:59], v236 offset:1024
    ds_read_b64_tr_b16 v[60:61], v236 offset:512
    ds_read_b64_tr_b16 v[62:63], v236 offset:1536
    v_mul_f32 v72, v7, v72
    v_mul_f32 v73, v7, v73
    v_mul_f32 v74, v7, v74
    v_mul_f32 v75, v7, v75
    v_mul_f32 v76, v7, v76
    v_mul_f32 v77, v7, v77
    v_mul_f32 v78, v7, v78
    v_mul_f32 v79, v7, v79
    v_mul_f32 v80, v7, v80
    v_mul_f32 v81, v7, v81
    v_mul_f32 v82, v7, v82
    v_mul_f32 v83, v7, v83
    v_mul_f32 v84, v7, v84
    v_mul_f32 v85, v7, v85
    v_mul_f32 v86, v7, v86
    v_mul_f32 v87, v7, v87
    v_mul_f32 v88, v7, v88
    v_mul_f32 v89, v7, v89
    v_mul_f32 v90, v7, v90
    v_mul_f32 v91, v7, v91
    v_mul_f32 v92, v7, v92
    v_mul_f32 v93, v7, v93
    v_mul_f32 v94, v7, v94
    v_mul_f32 v95, v7, v95
    v_mul_f32 v96, v7, v96
    v_mul_f32 v97, v7, v97
    v_mul_f32 v98, v7, v98
    v_mul_f32 v99, v7, v99
    v_mul_f32 v100, v7, v100
    v_mul_f32 v101, v7, v101
    v_mul_f32 v102, v7, v102
    v_mul_f32 v103, v7, v103
    s_waitcnt lgkmcnt(0)
    s_branch L_tl4
L_ore0:
    s_sub_u32 s69, s69, 1
    s_cbranch_scc1 L_ogive0
    s_waitcnt vmcnt(0)
    buffer_load_dwordx4 v[104:107], v1, s[20:23], s79 offen offset:0 sc1
    buffer_load_dwordx4 v[108:111], v1, s[20:23], s79 offen offset:2048 sc1
    buffer_load_dwordx4 v[112:115], v1, s[20:23], s58 offen offset:0 sc1
    buffer_load_dwordx4 v[116:119], v1, s[20:23], s58 offen offset:2048 sc1
    buffer_load_dwordx4 v[120:123], v1, s[20:23], s79 offen offset:1024 sc1
    buffer_load_dwordx4 v[124:127], v1, s[20:23], s79 offen offset:3072 sc1
    buffer_load_dwordx4 v[128:131], v1, s[20:23], s58 offen offset:1024 sc1
    buffer_load_dwordx4 v[132:135], v1, s[20:23], s58 offen offset:3072 sc1
    s_waitcnt vmcnt(7)
    v_max3_u32 v2, v104, v105, v106
    v_max_u32 v2, v2, v107
    v_cmp_eq_u32 vcc, -1, v2
    s_cbranch_vccnz L_ore0
    s_branch L_ook0
L_ogive0:
    s_mov_b32 s69, 0
    s_branch L_ook0
L_ore1:
    s_sub_u32 s69, s69, 1
    s_cbranch_scc1 L_ogive1
    s_waitcnt vmcnt(0)
    buffer_load_dwordx4 v[108:111], v1, s[20:23], s79 offen offset:2048 sc1
    buffer_load_dwordx4 v[112:115], v1, s[20:23], s58 offen offset:0 sc1
    buffer_load_dwordx4 v[116:119], v1, s[20:23], s58 offen offset:2048 sc1
    buffer_load_dwordx4 v[120:123], v1, s[20:23], s79 offen offset:1024 sc1
    buffer_load_dwordx4 v[124:127], v1, s[20:23], s79 offen offset:3072 sc1
    buffer_load_dwordx4 v[128:131], v1, s[20:23], s58 offen offset:1024 sc1
    buffer_load_dwordx4 v[132:135], v1, s[20:23], s58 offen offset:3072 sc1
    s_waitcnt vmcnt(6)
    v_max3_u32 v2, v108, v109, v110
    v_max_u32 v2, v2, v111
    v_cmp_eq_u32 vcc, -1, v2
    s_cbranch_vccnz L_ore1
    s_branch L_ook1
L_ogive1:
    s_mov_b32 s69, 0
    s_branch L_ook1
L_ore2:
    s_sub_u32 s69, s69, 1
    s_cbranch_scc1 L_ogive2
    s_waitcnt vmcnt(0)
    buffer_load_dwordx4 v[112:115], v1, s[20:23], s58 offen offset:0 sc1
    buffer_load_dwordx4 v[116:119], v1, s[20:23], s58 offen offset:2048 sc1
    buffer_load_dwordx4 v[120:123], v1, s[20:23], s79 offen offset:1024 sc1
    buffer_load_dwordx4 v[124:127], v1, s[20:23], s79 offen offset:3072 sc1
    buffer_load_dwordx4 v[128:131], v1, s[20:23], s58 offen offset:1024 sc1
    buffer_load_dwordx4 v[132:135], v1, s[20:23], s58 offen offset:3072 sc1
    s_waitcnt vmcnt(5)
    v_max3_u32 v2, v112, v113, v114
    v_max_u32 v2, v2, v115
    v_cmp_eq_u32 vcc, -1, v2
    s_cbranch_vccnz L_ore2
    s_branch L_ook2
L_ogive2:
    s_mov_b32 s69, 0
    s_branch L_ook2
L_ore3:
    s_sub_u32 s69, s69, 1
    s_cbranch_scc1 L_ogive3
    s_waitcnt vmcnt(0)
    buffer_load_dwordx4 v[116:119], v1, s[20:23], s58 offen offset:2048 sc1
    buffer_load_dwordx4 v[120:123], v1, s[20:23], s79 offen offset:1024 sc1
    buffer_load_dwordx4 v[124:127], v1, s[20:23], s79 offen offset:3072 sc1
    buffer_load_dwordx4 v[128:131], v1, s[20:23], s58 offen offset:1024 sc1
    buffer_load_dwordx4 v[132:135], v1, s[20:23], s58 offen offset:3072 sc1
    s_waitcnt vmcnt(4)
    v_max3_u32 v2, v116, v117, v118
    v_max_u32 v2, v2, v119
    v_cmp_eq_u32 vcc, -1, v2
    s_cbranch_vccnz L_ore3
    s_branch L_ook3
L_ogive3:
    s_mov_b32 s69, 0
    s_branch L_ook3
L_ore4:
    s_sub_u32 s69, s69, 1
    s_cbranch_scc1 L_ogive4
    s_waitcnt vmcnt(0)
    buffer_load_dwordx4 v[120:123], v1, s[20:23], s79 offen offset:1024 sc1
    buffer_load_dwordx4 v[124:127], v1, s[20:23], s79 offen offset:3072 sc1
    buffer_load_dwordx4 v[128:131], v1, s[20:23], s58 offen offset:1024 sc1
    buffer_load_dwordx4 v[132:135], v1, s[20:23], s58 offen offset:3072 sc1
    s_waitcnt vmcnt(3)
    v_max3_u32 v2, v120, v121, v122
    v_max_u32 v2, v2, v123
    v_cmp_eq_u32 vcc, -1, v2
    s_cbranch_vccnz L_ore4
    s_branch L_ook4
L_ogive4:
    s_mov_b32 s69, 0
    s_branch L_ook4
L_ore5:
    s_sub_u32 s69, s69, 1
    s_cbranch_scc1 L_ogive5
    s_waitcnt vmcnt(0)
    buffer_load_dwordx4 v[124:127], v1, s[20:23], s79 offen offset:3072 sc1
    buffer_load_dwordx4 v[128:131], v1, s[20:23], s58 offen offset:1024 sc1
    buffer_load_dwordx4 v[132:135], v1, s[20:23], s58 offen offset:3072 sc1
    s_waitcnt vmcnt(2)
    v_max3_u32 v2, v124, v125, v126
    v_max_u32 v2, v2, v127
    v_cmp_eq_u32 vcc, -1, v2
    s_cbranch_vccnz L_ore5
    s_branch L_ook5
L_ogive5:
    s_mov_b32 s69, 0
    s_branch L_ook5
L_ore6:
    s_sub_u32 s69, s69, 1
    s_cbranch_scc1 L_ogive6
    s_waitcnt vmcnt(0)
    buffer_load_dwordx4 v[128:131], v1, s[20:23], s58 offen offset:1024 sc1
    buffer_load_dwordx4 v[132:135], v1, s[20:23], s58 offen offset:3072 sc1
    s_waitcnt vmcnt(1)
    v_max3_u32 v2, v128, v129, v130
    v_max_u32 v2, v2, v131
    v_cmp_eq_u32 vcc, -1, v2
    s_cbranch_vccnz L_ore6
    s_branch L_ook6
L_ogive6:
    s_mov_b32 s69, 0
    s_branch L_ook6
L_ore7:
    s_sub_u32 s69, s69, 1
    s_cbranch_scc1 L_ogive7
    s_waitcnt vmcnt(0)
    buffer_load_dwordx4 v[132:135], v1, s[20:23], s58 offen offset:3072 sc1
    s_waitcnt vmcnt(0)
    v_max3_u32 v2, v132, v133, v134
    v_max_u32 v2, v2, v135
    v_cmp_eq_u32 vcc, -1, v2
    s_cbranch_vccnz L_ore7
    s_branch L_ook7
L_ogive7:
    s_mov_b32 s69, 0
    s_branch L_ook7
L_e2:
    s_add_u32 m0, s58, 0x26000
    s_bfe_u32 s74, s75, 0x30008
    s_lshl_b32 s72, s74, 16
    buffer_load_dwordx4 v251, s[16:19], s72 offen lds
    s_mov_b32 s60, 0xffff
    s_mov_b32 s61, 0xffff
    s_add_u32 m0, s58, 0x20000
    s_lshl_b32 s72, s74, 7
    buffer_load_dwordx4 v249, s[4:7], s72 offen lds
    s_lshl_b32 s68, s53, 2
    s_add_u32 s68, s68, s52
    s_add_u32 m0, s58, 0x21000
    s_add_u32 s72, s72, 0x8000
    buffer_load_dwordx4 v249, s[4:7], s72 offen lds
    s_lshl_b32 s69, s68, 5
    s_lshl_b32 s70, s81, 1
    s_add_u32 m0, s58, 0x22000
    s_add_u32 s72, s72, 0x8000
    buffer_load_dwordx4 v249, s[4:7], s72 offen lds
    s_add_u32 s69, s69, s70
    s_add_u32 s69, s69, s51
    s_add_u32 m0, s58, 0x23000
    s_add_u32 s72, s72, 0x8000
    buffer_load_dwordx4 v249, s[4:7], s72 offen lds
    s_lshl_b32 s69, s69, 10
    s_add_u32 s78, s69, 0x100000
    s_waitcnt vmcnt(6) lgkmcnt(0)
    s_branch L_e2_r
L_d3:
    s_add_u32 m0, s58, 0x8000
    s_bfe_u32 s74, s75, 0x30008
    s_mul_i32 s72, s74, 229376
    buffer_load_dwordx4 v250, s[8:11], s72 offen lds
    s_mov_b32 s60, 0xffff
    s_mov_b32 s61, 0xffff
    s_lshl_b32 s68, s53, 2
    s_add_u32 s68, s68, s52
    s_lshl_b32 s69, s68, 5
    s_add_u32 m0, s58, 0x14000
    s_nop 0
    buffer_load_dwordx4 v250, s[12:15], s72 offen lds
    s_lshl_b32 s70, s81, 1
    s_add_u32 s69, s69, s70
    s_add_u32 s69, s69, s51
    s_lshl_b32 s69, s69, 10
    s_add_u32 s78, s69, 0x100000
    s_add_u32 m0, s58, 0x9000
    s_add_u32 s72, s72, 0xe000
    buffer_load_dwordx4 v250, s[8:11], s72 offen lds
    v_mov_b32 v16, -1
    v_mov_b32 v17, -1
    v_mov_b32 v18, -1
    v_mov_b32 v19, -1
    v_mov_b32 v11, 1
    s_add_u32 m0, s58, 0x15000
    s_nop 0
    buffer_load_dwordx4 v250, s[12:15], s72 offen lds
    v_mov_b32 v12, 0
    v_and_b32 v15, 31, v0
    v_lshlrev_b32 v15, 2, v15
    s_mov_b32 s68, 0x110000
    s_mov_b32 s69, 0x110000
    s_add_u32 m0, s58, 0xa000
    s_add_u32 s72, s72, 0xe000
    buffer_load_dwordx4 v250, s[8:11], s72 offen lds
    v_mov_b32 v3, 0x3f803f80
    v_cndmask_b32 v24, 0, v3, s[68:69]
    v_mov_b32 v25, v24
    v_mov_b32 v26, v24
    v_mov_b32 v27, v24
    s_add_u32 m0, s58, 0x16000
    s_nop 0
    buffer_load_dwordx4 v250, s[12:15], s72 offen lds
    v_mov_b32 v40, v24
    v_mov_b32 v41, v24
    v_mov_b32 v42, v24
    v_mov_b32 v43, v24
    v_mov_b32 v44, v24
    s_add_u32 m0, s58, 0xb000
    s_add_u32 s72, s72, 0xe000
    buffer_load_dwordx4 v250, s[8:11], s72 offen lds
    v_mov_b32 v45, v24
    v_mov_b32 v46, v24
    v_mov_b32 v47, v24
    v_mov_b32 v48, v24
    v_mov_b32 v49, v24
    s_branch L_d3_r
L_e3:
    s_add_u32 m0, s58, 0x17000
    s_bfe_u32 s74, s75, 0x30008
    s_mul_i32 s72, s74, 229376
    s_add_u32 s72, s72, 0x2a000
    buffer_load_dwordx4 v250, s[12:15], s72 offen lds
    v_mov_b32 v16, -1
    v_mov_b32 v17, -1
    s_add_u32 m0, s58, 0x24000
    s_bfe_u32 s74, s75, 0x3000c
    s_lshl_b32 s72, s74, 16
    buffer_load_dwordx4 v251, s[16:19], s72 offen lds
    v_mov_b32 v18, -1
    v_mov_b32 v19, -1
    s_add_u32 m0, s58, 0x18000
    s_lshl_b32 s72, s74, 7
    buffer_load_dwordx4 v249, s[4:7], s72 offen lds
    v_mov_b32 v11, 1
    v_mov_b32 v12, 0
    s_add_u32 m0, s58, 0x19000
    s_add_u32 s72, s72, 0x8000
    buffer_load_dwordx4 v249, s[4:7], s72 offen lds
    v_and_b32 v15, 31, v0
    v_lshlrev_b32 v15, 2, v15
    s_add_u32 m0, s58, 0x1a000
    s_add_u32 s72, s72, 0x8000
    buffer_load_dwordx4 v249, s[4:7], s72 offen lds
    s_mov_b32 s68, 0x110000
    s_mov_b32 s69, 0x110000
    s_add_u32 m0, s58, 0x1b000
    s_add_u32 s72, s72, 0x8000
    buffer_load_dwordx4 v249, s[4:7], s72 offen lds
    v_mov_b32 v3, 0x3f803f80
    v_cndmask_b32 v24, 0, v3, s[68:69]
    s_add_u32 m0, s58, 0x0
    s_mul_i32 s72, s74, 229376
    buffer_load_dwordx4 v250, s[8:11], s72 offen lds
    v_mov_b32 v25, v24
    v_mov_b32 v26, v24
    s_add_u32 m0, s58, 0xc000
    s_nop 0
    buffer_load_dwordx4 v250, s[12:15], s72 offen lds
    v_mov_b32 v27, v24
    v_mov_b32 v40, v24
    s_waitcnt vmcnt(7) lgkmcnt(0)
    s_branch L_e3_r
L_d4:
    s_add_u32 m0, s58, 0x1000
    s_bfe_u32 s74, s75, 0x3000c
    s_mul_i32 s72, s74, 229376
    s_add_u32 s72, s72, 0xe000
    buffer_load_dwordx4 v250, s[8:11], s72 offen lds
    v_mov_b32 v50, v24
    v_mov_b32 v51, v24
    v_mov_b32 v52, v24
    v_mov_b32 v53, v24
    v_mov_b32 v54, v24
    s_add_u32 m0, s58, 0xd000
    s_nop 0
    buffer_load_dwordx4 v250, s[12:15], s72 offen lds
    v_mov_b32 v55, v24
    s_lshl_b32 s68, s53, 2
    s_add_u32 s68, s68, s52
    s_mul_i32 s69, s68, 112
    s_add_u32 m0, s58, 0x2000
    s_add_u32 s72, s72, 0xe000
    buffer_load_dwordx4 v250, s[8:11], s72 offen lds
    s_lshl_b32 s70, s54, 3
    s_add_u32 s69, s69, s70
    s_lshl_b32 s70, s51, 2
    s_add_u32 s69, s69, s70
    s_and_b32 s70, s52, 1
    s_add_u32 m0, s58, 0xe000
    s_nop 0
    buffer_load_dwordx4 v250, s[12:15], s72 offen lds
    s_lshl_b32 s70, s70, 1
    s_add_u32 s69, s69, s70
    s_lshl_b32 s69, s69, 10
    s_add_u32 s80, s69, 0x400000
    s_mul_i32 s70, s70, 114688
    s_add_u32 m0, s58, 0x3000
    s_add_u32 s72, s72, 0xe000
    buffer_load_dwordx4 v250, s[8:11], s72 offen lds
    s_sub_u32 s70, 114688, s70
    s_add_u32 s3, s80, s70
    v_bfe_u32 v2, v0, 2, 2
    v_lshrrev_b32 v3, 5, v0
    v_lshl_add_u32 v2, v3, 2, v2
    s_add_u32 m0, s58, 0xf000
    s_nop 0
    buffer_load_dwordx4 v250, s[12:15], s72 offen lds
    v_lshlrev_b32 v2, 6, v2
    v_bfe_u32 v3, v0, 4, 1
    v_lshl_add_u32 v2, v3, 5, v2
    v_and_b32 v3, 3, v0
    v_lshl_add_u32 v2, v3, 3, v2
    s_add_u32 m0, s58, 0x25000
    s_bfe_u32 s74, s75, 0x30010
    s_lshl_b32 s72, s74, 16
    buffer_load_dwordx4 v251, s[16:19], s72 offen lds
    s_lshr_b32 s68, s50, 1
    s_lshl_b32 s68, s68, 11
    v_add_u32 v9, s68, v2
    v_add_u32 v8, 0x20000, v1
    v_add_u32 v29, 0x24000, v1
    s_branch L_d4_r
L_e4:
    s_add_u32 m0, s58, 0x1c000
    s_bfe_u32 s74, s75, 0x30010
    s_lshl_b32 s72, s74, 7
    buffer_load_dwordx4 v249, s[4:7], s72 offen lds
    v_mov_b32 v41, v24
    v_mov_b32 v42, v24
    s_add_u32 m0, s58, 0x1d000
    s_add_u32 s72, s72, 0x8000
    buffer_load_dwordx4 v249, s[4:7], s72 offen lds
    v_mov_b32 v43, v24
    v_mov_b32 v44, v24
    s_add_u32 m0, s58, 0x1e000
    s_add_u32 s72, s72, 0x8000
    buffer_load_dwordx4 v249, s[4:7], s72 offen lds
    v_mov_b32 v45, v24
    v_mov_b32 v46, v24
    s_add_u32 m0, s58, 0x1f000
    s_add_u32 s72, s72, 0x8000
    buffer_load_dwordx4 v249, s[4:7], s72 offen lds
    v_mov_b32 v47, v24
    v_mov_b32 v48, v24
    s_add_u32 m0, s58, 0x4000
    s_mul_i32 s72, s74, 229376
    buffer_load_dwordx4 v250, s[8:11], s72 offen lds
    v_mov_b32 v49, v24
    v_mov_b32 v50, v24
    s_add_u32 m0, s58, 0x10000
    s_nop 0
    buffer_load_dwordx4 v250, s[12:15], s72 offen lds
    v_mov_b32 v51, v24
    v_mov_b32 v52, v24
    s_add_u32 m0, s58, 0x5000
    s_add_u32 s72, s72, 0xe000
    buffer_load_dwordx4 v250, s[8:11], s72 offen lds
    v_mov_b32 v53, v24
    v_mov_b32 v54, v24
    s_add_u32 m0, s58, 0x11000
    s_nop 0
    buffer_load_dwordx4 v250, s[12:15], s72 offen lds
    v_mov_b32 v55, v24
    s_waitcnt vmcnt(8) lgkmcnt(0)
    s_branch L_e4_r
L_d5:
    s_add_u32 m0, s58, 0x6000
    s_bfe_u32 s74, s75, 0x30010
    s_mul_i32 s72, s74, 229376
    s_add_u32 s72, s72, 0x1c000
    buffer_load_dwordx4 v250, s[8:11], s72 offen lds
    v_bfe_u32 v2, v0, 2, 3
    v_lshlrev_b32 v2, 10, v2
    v_lshrrev_b32 v3, 5, v0
    v_lshl_add_u32 v2, v3, 6, v2
    v_and_b32 v3, 3, v0
    s_add_u32 m0, s58, 0x12000
    s_nop 0
    buffer_load_dwordx4 v250, s[12:15], s72 offen lds
    v_lshl_add_u32 v2, v3, 4, v2
    s_lshl_b32 s69, s56, 7
    v_add_u32 v10, s69, v2
    v_min_u32 v2, 13, v0
    v_lshlrev_b32 v2, 7, v2
    s_add_u32 m0, s58, 0x7000
    s_add_u32 s72, s72, 0xe000
    buffer_load_dwordx4 v250, s[8:11], s72 offen lds
    s_lshr_b32 s68, s55, 1
    s_lshl_b32 s68, s68, 11
    s_add_u32 s68, s68, 0x30000
    v_add_u32 v13, s68, v2
    s_lshl_b32 s68, s55, 1
    s_add_u32 m0, s58, 0x13000
    s_nop 0
    buffer_load_dwordx4 v250, s[12:15], s72 offen lds
    s_and_b32 s69, s50, 1
    s_add_u32 s68, s68, s69
    s_lshl_b32 s69, s68, 15
    s_lshr_b32 s76, s50, 1
    s_and_b32 s76, s50, 2
    s_add_u32 m0, s58, 0x26000
    s_bfe_u32 s74, s75, 0x30014
    s_lshl_b32 s72, s74, 16
    buffer_load_dwordx4 v251, s[16:19], s72 offen lds
    s_add_u32 s76, s76, s51
    s_lshl_b32 s70, s76, 13
    s_add_u32 s69, s69, s70
    s_add_u32 s79, s69, 0x100000
    v_and_b32 v2, 31, v0
    s_add_u32 m0, s58, 0x20000
    s_lshl_b32 s72, s74, 7
    buffer_load_dwordx4 v249, s[4:7], s72 offen lds
    v_lshrrev_b32 v3, 5, v0
    v_and_b32 v4, 7, v0
    v_xor_b32 v3, v3, v4
    v_lshlrev_b32 v3, 4, v3
    v_lshl_add_u32 v3, v2, 8, v3
    s_add_u32 m0, s58, 0x21000
    s_add_u32 s72, s72, 0x8000
    buffer_load_dwordx4 v249, s[4:7], s72 offen lds
    s_and_b32 s69, s50, 1
    s_lshl_b32 s69, s69, 15
    s_lshr_b32 s70, s50, 1
    s_lshl_b32 s71, s70, 13
    s_add_u32 s59, s71, s69
    s_branch L_d5_r
L_e5:
    s_add_u32 m0, s58, 0x22000
    s_bfe_u32 s74, s75, 0x30014
    s_lshl_b32 s72, s74, 7
    s_add_u32 s72, s72, 0x10000
    buffer_load_dwordx4 v249, s[4:7], s72 offen lds
    s_add_u32 m0, s58, 0x23000
    s_add_u32 s72, s72, 0x8000
    buffer_load_dwordx4 v249, s[4:7], s72 offen lds
    s_add_u32 m0, s58, 0x8000
    s_mul_i32 s72, s74, 229376
    buffer_load_dwordx4 v250, s[8:11], s72 offen lds
    s_add_u32 m0, s58, 0x14000
    s_nop 0
    buffer_load_dwordx4 v250, s[12:15], s72 offen lds
    s_add_u32 m0, s58, 0x9000
    s_add_u32 s72, s72, 0xe000
    buffer_load_dwordx4 v250, s[8:11], s72 offen lds
    s_add_u32 m0, s58, 0x15000
    s_nop 0
    buffer_load_dwordx4 v250, s[12:15], s72 offen lds
    s_add_u32 m0, s58, 0xa000
    s_add_u32 s72, s72, 0xe000
    buffer_load_dwordx4 v250, s[8:11], s72 offen lds
    s_add_u32 m0, s58, 0x16000
    s_nop 0
    buffer_load_dwordx4 v250, s[12:15], s72 offen lds
    s_waitcnt vmcnt(8) lgkmcnt(0)
    s_branch L_e5_r
L_d6:
    s_add_u32 m0, s58, 0xb000
    s_bfe_u32 s74, s75, 0x30014
    s_mul_i32 s72, s74, 229376
    s_add_u32 s72, s72, 0x2a000
    buffer_load_dwordx4 v250, s[8:11], s72 offen lds
    s_add_u32 s71, s59, 0x18000
    v_add_u32 v30, s71, v3
    v_lshrrev_b32 v2, 3, v0
    v_lshlrev_b32 v3, 1, v4
    v_xor_b32 v3, v3, v2
    s_add_u32 m0, s58, 0x17000
    s_nop 0
    buffer_load_dwordx4 v250, s[12:15], s72 offen lds
    v_lshlrev_b32 v3, 4, v3
    v_lshl_add_u32 v3, v2, 8, v3
    s_lshl_b32 s71, s70, 11
    s_add_u32 s71, s71, s69
    s_add_u32 s71, s71, 0x18000
    s_add_u32 m0, s58, 0x24000
    s_bfe_u32 s74, s75, 0x30018
    s_lshl_b32 s72, s74, 16
    buffer_load_dwordx4 v251, s[16:19], s72 offen lds
    v_add_u32 v31, s71, v3
    v_lshlrev_b32 v4, 4, v4
    v_lshl_add_u32 v12, v2, 10, v4
    s_lshl_b32 s70, s55, 16
    s_add_u32 s59, s59, s70
    s_add_u32 m0, s58, 0x18000
    s_lshl_b32 s72, s74, 7
    buffer_load_dwordx4 v249, s[4:7], s72 offen lds
    s_lshl_b32 s70, s56, 7
    s_add_u32 s59, s59, s70
    v_mov_b32 v28, 0xdddd
    v_lshrrev_b32 v2, 4, v0
    v_lshl_add_u32 v254, v2, 8, v1
    s_add_u32 m0, s58, 0x19000
    s_add_u32 s72, s72, 0x8000
    buffer_load_dwordx4 v249, s[4:7], s72 offen lds
    v_mov_b32 v56, 0
    v_mov_b32 v57, 0
    v_mov_b32 v58, 0
    v_mov_b32 v59, 0
    v_mov_b32 v60, 0
    s_add_u32 m0, s58, 0x1a000
    s_add_u32 s72, s72, 0x8000
    buffer_load_dwordx4 v249, s[4:7], s72 offen lds
    v_mov_b32 v61, 0
    v_mov_b32 v62, 0
    v_mov_b32 v63, 0
    v_mov_b32 v64, 0
    v_mov_b32 v65, 0
    s_add_u32 m0, s58, 0x1b000
    s_add_u32 s72, s72, 0x8000
    buffer_load_dwordx4 v249, s[4:7], s72 offen lds
    v_mov_b32 v66, 0
    v_mov_b32 v67, 0
    v_mov_b32 v68, 0
    v_mov_b32 v69, 0
    v_mov_b32 v70, 0
    s_branch L_d6_r
L_e6:
    s_add_u32 m0, s58, 0x0
    s_bfe_u32 s74, s75, 0x30018
    s_mul_i32 s72, s74, 229376
    buffer_load_dwordx4 v250, s[8:11], s72 offen lds
    s_add_u32 m0, s58, 0xc000
    s_nop 0
    buffer_load_dwordx4 v250, s[12:15], s72 offen lds
    s_add_u32 m0, s58, 0x1000
    s_add_u32 s72, s72, 0xe000
    buffer_load_dwordx4 v250, s[8:11], s72 offen lds
    s_add_u32 m0, s58, 0xd000
    s_nop 0
    buffer_load_dwordx4 v250, s[12:15], s72 offen lds
    s_add_u32 m0, s58, 0x2000
    s_add_u32 s72, s72, 0xe000
    buffer_load_dwordx4 v250, s[8:11], s72 offen lds
    s_add_u32 m0, s58, 0xe000
    s_nop 0
    buffer_load_dwordx4 v250, s[12:15], s72 offen lds
    s_add_u32 m0, s58, 0x3000
    s_add_u32 s72, s72, 0xe000
    buffer_load_dwordx4 v250, s[8:11], s72 offen lds
    s_add_u32 m0, s58, 0xf000
    s_nop 0
    buffer_load_dwordx4 v250, s[12:15], s72 offen lds
    s_waitcnt vmcnt(8) lgkmcnt(0)
    s_branch L_e6_r
L_d7:
    s_add_u32 m0, s58, 0x25000
    s_bfe_u32 s74, s75, 0x3001c
    s_lshl_b32 s72, s74, 16
    buffer_load_dwordx4 v251, s[16:19], s72 offen lds
    v_mov_b32 v71, 0
    v_mov_b32 v72, 0
    v_mov_b32 v73, 0
    v_mov_b32 v74, 0
    v_mov_b32 v75, 0
    s_add_u32 m0, s58, 0x1c000
    s_lshl_b32 s72, s74, 7
    buffer_load_dwordx4 v249, s[4:7], s72 offen lds
    v_mov_b32 v76, 0
    v_mov_b32 v77, 0
    v_mov_b32 v78, 0
    v_mov_b32 v79, 0
    v_mov_b32 v80, 0
    s_add_u32 m0, s58, 0x1d000
    s_add_u32 s72, s72, 0x8000
    buffer_load_dwordx4 v249, s[4:7], s72 offen lds
    v_mov_b32 v81, 0
    v_mov_b32 v82, 0
    v_mov_b32 v83, 0
    v_mov_b32 v84, 0
    v_mov_b32 v85, 0
    s_add_u32 m0, s58, 0x1e000
    s_add_u32 s72, s72, 0x8000
    buffer_load_dwordx4 v249, s[4:7], s72 offen lds
    v_mov_b32 v86, 0
    v_mov_b32 v87, 0
    v_mov_b32 v88, 0
    v_mov_b32 v89, 0
    v_mov_b32 v90, 0
    s_add_u32 m0, s58, 0x1f000
    s_add_u32 s72, s72, 0x8000
    buffer_load_dwordx4 v249, s[4:7], s72 offen lds
    v_mov_b32 v91, 0
    v_mov_b32 v92, 0
    v_mov_b32 v93, 0
    v_mov_b32 v94, 0
    v_mov_b32 v95, 0
    s_add_u32 m0, s58, 0x4000
    s_mul_i32 s72, s74, 229376
    buffer_load_dwordx4 v250, s[8:11], s72 offen lds
    v_mov_b32 v96, 0
    v_mov_b32 v97, 0
    v_mov_b32 v98, 0
    v_mov_b32 v99, 0
    v_mov_b32 v100, 0
    s_add_u32 m0, s58, 0x10000
    s_nop 0
    buffer_load_dwordx4 v250, s[12:15], s72 offen lds
    v_mov_b32 v101, 0
    v_mov_b32 v102, 0
    v_mov_b32 v103, 0
    v_mov_b32 v252, 0xc0135761
    v_mov_b32 v253, 0xbdd2d3e8
    s_branch L_d7_r
L_e7:
    s_add_u32 m0, s58, 0x5000
    s_bfe_u32 s74, s75, 0x3001c
    s_mul_i32 s72, s74, 229376
    s_add_u32 s72, s72, 0xe000
    buffer_load_dwordx4 v250, s[8:11], s72 offen lds
    s_add_u32 m0, s58, 0x11000
    s_nop 0
    buffer_load_dwordx4 v250, s[12:15], s72 offen lds
    s_add_u32 m0, s58, 0x6000
    s_add_u32 s72, s72, 0xe000
    buffer_load_dwordx4 v250, s[8:11], s72 offen lds
    s_add_u32 m0, s58, 0x12000
    s_nop 0
    buffer_load_dwordx4 v250, s[12:15], s72 offen lds
    s_add_u32 m0, s58, 0x7000
    s_add_u32 s72, s72, 0xe000
    buffer_load_dwordx4 v250, s[8:11], s72 offen lds
    s_add_u32 m0, s58, 0x13000
    s_nop 0
    buffer_load_dwordx4 v250, s[12:15], s72 offen lds
    s_waitcnt vmcnt(6) lgkmcnt(0)
    s_branch L_e7_r
L_trA:
    s_setprio 1
    s_cmp_ge_u32 s54, 14
    s_cbranch_scc1 L_nogA0
    s_mov_b32 s68, 0x1f800
    buffer_load_dwordx4 v[20:23], v1, s[64:67], s68 offen sc1
    buffer_store_dwordx4 v[16:19], v1, s[20:23], s78 offen sc1
.p2align 3
    v_mul_f32 v184, v104, v104
    v_mul_f32 v185, v105, v105
    v_mul_f32 v186, v106, v106
    v_mul_f32 v187, v107, v107
    v_mul_f32 v188, v108, v108
    v_mul_f32 v189, v109, v109
    v_mul_f32 v190, v110, v110
    v_mul_f32 v191, v111, v111
    v_fma_f32 v184, v184, v253, v252
    v_fma_f32 v185, v185, v253, v252
    v_fma_f32 v186, v186, v253, v252
    v_fma_f32 v187, v187, v253, v252
    v_fma_f32 v188, v188, v253, v252
    v_fma_f32 v189, v189, v253, v252
    v_fma_f32 v190, v190, v253, v252
    v_fma_f32 v191, v191, v253, v252
    v_mul_f32 v184, v184, v104
    v_mul_f32 v185, v185, v105
    v_mul_f32 v186, v186, v106
    v_mul_f32 v187, v187, v107
    v_mul_f32 v188, v188, v108
    v_mul_f32 v189, v189, v109
    v_mul_f32 v190, v190, v110
    v_mul_f32 v191, v191, v111
    v_exp_f32 v184, v184
    v_exp_f32 v185, v185
    v_exp_f32 v186, v186
    v_exp_f32 v187, v187
    v_exp_f32 v188, v188
    v_exp_f32 v189, v189
    v_exp_f32 v190, v190
    v_exp_f32 v191, v191
    v_add_f32 v184, 1.0, v184
    v_add_f32 v185, 1.0, v185
    v_add_f32 v186, 1.0, v186
    v_add_f32 v187, 1.0, v187
    v_add_f32 v188, 1.0, v188
    v_add_f32 v189, 1.0, v189
    v_add_f32 v190, 1.0, v190
    v_add_f32 v191, 1.0, v191
    v_rcp_f32 v184, v184
    v_rcp_f32 v185, v185
    v_rcp_f32 v186, v186
    v_rcp_f32 v187, v187
    v_rcp_f32 v188, v188
    v_rcp_f32 v189, v189
    v_rcp_f32 v190, v190
    v_rcp_f32 v191, v191
    v_mul_f32 v104, v104, v112
    v_mul_f32 v105, v105, v113
    v_mul_f32 v106, v106, v114
    v_mul_f32 v107, v107, v115
    v_mul_f32 v108, v108, v116
    v_mul_f32 v109, v109, v117
    v_mul_f32 v110, v110, v118
    v_mul_f32 v111, v111, v119
    v_mul_f32 v104, v104, v184
    v_mul_f32 v105, v105, v185
    v_mul_f32 v106, v106, v186
    v_mul_f32 v107, v107, v187
    v_mul_f32 v108, v108, v188
    v_mul_f32 v109, v109, v189
    v_mul_f32 v110, v110, v190
    v_mul_f32 v111, v111, v191
    v_cvt_pk_bf16_f32 v192, v104, v105
    v_cvt_pk_bf16_f32 v193, v106, v107
    v_cvt_pk_bf16_f32 v194, v108, v109
    v_cvt_pk_bf16_f32 v195, v110, v111
    buffer_store_dwordx4 v[192:195], v254, s[20:23], s80 offen offset:0 sc1
    v_mul_f32 v184, v120, v120
    v_mul_f32 v185, v121, v121
    v_mul_f32 v186, v122, v122
    v_mul_f32 v187, v123, v123
    v_mul_f32 v188, v124, v124
    v_mul_f32 v189, v125, v125
    v_mul_f32 v190, v126, v126
    v_mul_f32 v191, v127, v127
    v_fma_f32 v184, v184, v253, v252
    v_fma_f32 v185, v185, v253, v252
    v_fma_f32 v186, v186, v253, v252
    v_fma_f32 v187, v187, v253, v252
    v_fma_f32 v188, v188, v253, v252
    v_fma_f32 v189, v189, v253, v252
    v_fma_f32 v190, v190, v253, v252
    v_fma_f32 v191, v191, v253, v252
    v_mul_f32 v184, v184, v120
    v_mul_f32 v185, v185, v121
    v_mul_f32 v186, v186, v122
    v_mul_f32 v187, v187, v123
    v_mul_f32 v188, v188, v124
    v_mul_f32 v189, v189, v125
    v_mul_f32 v190, v190, v126
    v_mul_f32 v191, v191, v127
    v_exp_f32 v184, v184
    v_exp_f32 v185, v185
    v_exp_f32 v186, v186
    v_exp_f32 v187, v187
    v_exp_f32 v188, v188
    v_exp_f32 v189, v189
    v_exp_f32 v190, v190
    v_exp_f32 v191, v191
    v_add_f32 v184, 1.0, v184
    v_add_f32 v185, 1.0, v185
    v_add_f32 v186, 1.0, v186
    v_add_f32 v187, 1.0, v187
    v_add_f32 v188, 1.0, v188
    v_add_f32 v189, 1.0, v189
    v_add_f32 v190, 1.0, v190
    v_add_f32 v191, 1.0, v191
    v_rcp_f32 v184, v184
    v_rcp_f32 v185, v185
    v_rcp_f32 v186, v186
    v_rcp_f32 v187, v187
    v_rcp_f32 v188, v188
    v_rcp_f32 v189, v189
    v_rcp_f32 v190, v190
    v_rcp_f32 v191, v191
    v_mul_f32 v120, v120, v128
    v_mul_f32 v121, v121, v129
    v_mul_f32 v122, v122, v130
    v_mul_f32 v123, v123, v131
    v_mul_f32 v124, v124, v132
    v_mul_f32 v125, v125, v133
    v_mul_f32 v126, v126, v134
    v_mul_f32 v127, v127, v135
    v_mul_f32 v120, v120, v184
    v_mul_f32 v121, v121, v185
    v_mul_f32 v122, v122, v186
    v_mul_f32 v123, v123, v187
    v_mul_f32 v124, v124, v188
    v_mul_f32 v125, v125, v189
    v_mul_f32 v126, v126, v190
    v_mul_f32 v127, v127, v191
    v_cvt_pk_bf16_f32 v196, v120, v121
    v_cvt_pk_bf16_f32 v197, v122, v123
    v_cvt_pk_bf16_f32 v198, v124, v125
    v_cvt_pk_bf16_f32 v199, v126, v127
    buffer_store_dwordx4 v[196:199], v254, s[20:23], s80 offen offset:256 sc1
L_nogA0:
    v_cvt_pk_bf16_f32 v16, v32, v33
    v_cvt_pk_bf16_f32 v17, v34, v35
    v_cvt_pk_bf16_f32 v18, v36, v37
    v_cvt_pk_bf16_f32 v19, v38, v39
    v_add_u32 v236, 0x10000, v9
    v_permlane16_swap_b32 v16, v18
    v_permlane16_swap_b32 v17, v19
    s_waitcnt vmcnt(3)
    s_setprio 0
    v_mfma_f32_32x32x16_bf16 v[104:119], v[20:23], v[16:19], 0
    s_barrier
    s_mov_b64 exec, s[60:61]
    buffer_load_dwordx4 v[24:27], v1, s[64:67], 0 offen offset:1280 sc1
    s_mov_b64 exec, -1
    s_lshl_b32 s68, s53, 2
    s_add_u32 s68, s68, s52
    s_lshl_b32 s68, s68, 7
    s_add_u32 s68, s68, 0x20000
    buffer_load_dword v6, v15, s[20:23], s68 offen sc1
    s_lshl_b32 s68, s55, 1
    s_and_b32 s69, s50, 1
    s_add_u32 s68, s68, s69
    s_lshl_b32 s68, s68, 7
    s_add_u32 s68, s68, 0x20000
    buffer_load_dword v7, v15, s[20:23], s68 offen sc1
    ds_read_b128 v[168:171], v8 offset:0
    ds_read_b128 v[172:175], v8 offset:2048
    s_mov_b64 exec, s[60:61]
    ds_read_b128 v[40:43], v8 offset:1024
    ds_read_b128 v[44:47], v8 offset:1280
    ds_read_b128 v[48:51], v8 offset:3072
    ds_read_b128 v[52:55], v8 offset:3328
    s_mov_b64 exec, -1
    s_add_u32 m0, s57, 0x24000
    s_add_u32 s68, s57, 0x4000
    buffer_load_dwordx4 v1, s[64:67], s68 offen sc1 lds
    s_add_u32 m0, s57, 0x26000
    s_add_u32 s68, s57, 0x6000
    buffer_load_dwordx4 v1, s[64:67], s68 offen sc1 lds
    s_mov_b32 s70, s76
    s_mul_i32 s73, s70, 458752
    s_and_b32 s69, s50, 1
    s_lshl_b32 s68, s69, 14
    s_add_u32 s73, s73, s68
    s_lshl_b32 s68, s55, 1
    s_add_u32 s68, s68, s69
    s_mul_i32 s68, s68, 112
    s_mul_i32 s69, s70, 28
    s_add_u32 s68, s68, s69
    s_lshl_b32 s68, s68, 10
    s_add_u32 s72, s68, 0x400000
    s_cmp_lt_u32 s54, 14
    s_cbranch_scc1 L_gA1
    s_waitcnt vmcnt(0)
    s_branch L_nogA1
.p2align 3
L_gA1:
    v_pk_mul_f32 v[184:185], v[136:137], v[136:137]
    v_pk_mul_f32 v[186:187], v[138:139], v[138:139]
    v_pk_mul_f32 v[188:189], v[140:141], v[140:141]
    v_pk_mul_f32 v[190:191], v[142:143], v[142:143]
    v_pk_fma_f32 v[184:185], v[184:185], v[252:253], v[252:253] op_sel:[0,1,0] op_sel_hi:[1,1,0]
    v_pk_fma_f32 v[186:187], v[186:187], v[252:253], v[252:253] op_sel:[0,1,0] op_sel_hi:[1,1,0]
    v_pk_fma_f32 v[188:189], v[188:189], v[252:253], v[252:253] op_sel:[0,1,0] op_sel_hi:[1,1,0]
    v_pk_fma_f32 v[190:191], v[190:191], v[252:253], v[252:253] op_sel:[0,1,0] op_sel_hi:[1,1,0]
    v_pk_mul_f32 v[184:185], v[184:185], v[136:137]
    v_pk_mul_f32 v[186:187], v[186:187], v[138:139]
    v_pk_mul_f32 v[188:189], v[188:189], v[140:141]
    v_pk_mul_f32 v[190:191], v[190:191], v[142:143]
    v_exp_f32 v184, v184
    v_exp_f32 v185, v185
    v_exp_f32 v186, v186
    v_exp_f32 v187, v187
    v_exp_f32 v188, v188
    v_exp_f32 v189, v189
    v_exp_f32 v190, v190
    v_exp_f32 v191, v191
    v_pk_add_f32 v[184:185], v[184:185], 1.0 op_sel_hi:[1,0]
    v_pk_add_f32 v[186:187], v[186:187], 1.0 op_sel_hi:[1,0]
    v_pk_add_f32 v[188:189], v[188:189], 1.0 op_sel_hi:[1,0]
    v_pk_add_f32 v[190:191], v[190:191], 1.0 op_sel_hi:[1,0]
    v_rcp_f32 v184, v184
    v_rcp_f32 v185, v185
    v_rcp_f32 v186, v186
    v_rcp_f32 v187, v187
    v_rcp_f32 v188, v188
    v_rcp_f32 v189, v189
    v_rcp_f32 v190, v190
    v_rcp_f32 v191, v191
    v_pk_mul_f32 v[136:137], v[136:137], v[144:145]
    v_pk_mul_f32 v[138:139], v[138:139], v[146:147]
    v_pk_mul_f32 v[140:141], v[140:141], v[148:149]
    v_pk_mul_f32 v[142:143], v[142:143], v[150:151]
    v_pk_mul_f32 v[136:137], v[136:137], v[184:185]
    v_pk_mul_f32 v[138:139], v[138:139], v[186:187]
    v_pk_mul_f32 v[140:141], v[140:141], v[188:189]
    v_pk_mul_f32 v[142:143], v[142:143], v[190:191]
    v_cvt_pk_bf16_f32 v200, v136, v137
    v_cvt_pk_bf16_f32 v201, v138, v139
    v_cvt_pk_bf16_f32 v202, v140, v141
    v_cvt_pk_bf16_f32 v203, v142, v143
    buffer_store_dwordx4 v[200:203], v254, s[20:23], s3 offen offset:0 sc1
    v_pk_mul_f32 v[184:185], v[152:153], v[152:153]
    v_pk_mul_f32 v[186:187], v[154:155], v[154:155]
    v_pk_mul_f32 v[188:189], v[156:157], v[156:157]
    v_pk_mul_f32 v[190:191], v[158:159], v[158:159]
    v_pk_fma_f32 v[184:185], v[184:185], v[252:253], v[252:253] op_sel:[0,1,0] op_sel_hi:[1,1,0]
    v_pk_fma_f32 v[186:187], v[186:187], v[252:253], v[252:253] op_sel:[0,1,0] op_sel_hi:[1,1,0]
    v_pk_fma_f32 v[188:189], v[188:189], v[252:253], v[252:253] op_sel:[0,1,0] op_sel_hi:[1,1,0]
    v_pk_fma_f32 v[190:191], v[190:191], v[252:253], v[252:253] op_sel:[0,1,0] op_sel_hi:[1,1,0]
    v_pk_mul_f32 v[184:185], v[184:185], v[152:153]
    v_pk_mul_f32 v[186:187], v[186:187], v[154:155]
    v_pk_mul_f32 v[188:189], v[188:189], v[156:157]
    v_pk_mul_f32 v[190:191], v[190:191], v[158:159]
    v_exp_f32 v184, v184
    v_exp_f32 v185, v185
    v_exp_f32 v186, v186
    v_exp_f32 v187, v187
    v_exp_f32 v188, v188
    v_exp_f32 v189, v189
    v_exp_f32 v190, v190
    v_exp_f32 v191, v191
    v_pk_add_f32 v[184:185], v[184:185], 1.0 op_sel_hi:[1,0]
    v_pk_add_f32 v[186:187], v[186:187], 1.0 op_sel_hi:[1,0]
    v_pk_add_f32 v[188:189], v[188:189], 1.0 op_sel_hi:[1,0]
    v_pk_add_f32 v[190:191], v[190:191], 1.0 op_sel_hi:[1,0]
    v_rcp_f32 v184, v184
    v_rcp_f32 v185, v185
    v_rcp_f32 v186, v186
    v_rcp_f32 v187, v187
    v_rcp_f32 v188, v188
    v_rcp_f32 v189, v189
    v_rcp_f32 v190, v190
    v_rcp_f32 v191, v191
    v_pk_mul_f32 v[152:153], v[152:153], v[160:161]
    v_pk_mul_f32 v[154:155], v[154:155], v[162:163]
    v_pk_mul_f32 v[156:157], v[156:157], v[164:165]
    v_pk_mul_f32 v[158:159], v[158:159], v[166:167]
    v_pk_mul_f32 v[152:153], v[152:153], v[184:185]
    v_pk_mul_f32 v[154:155], v[154:155], v[186:187]
    v_pk_mul_f32 v[156:157], v[156:157], v[188:189]
    v_pk_mul_f32 v[158:159], v[158:159], v[190:191]
    v_cvt_pk_bf16_f32 v204, v152, v153
    v_cvt_pk_bf16_f32 v205, v154, v155
    v_cvt_pk_bf16_f32 v206, v156, v157
    v_cvt_pk_bf16_f32 v207, v158, v159
    buffer_store_dwordx4 v[204:207], v254, s[20:23], s3 offen offset:256 sc1
L_nogA1:
    s_setprio 2
    s_waitcnt lgkmcnt(0)
    s_barrier
    v_exp_f32 v104, v104
    v_exp_f32 v105, v105
    v_exp_f32 v106, v106
    v_exp_f32 v107, v107
    v_exp_f32 v108, v108
    v_exp_f32 v109, v109
    v_mfma_f32_32x32x16_bf16 v[120:135], v[168:171], v[16:19], 0
    v_exp_f32 v110, v110
    v_exp_f32 v111, v111
    v_exp_f32 v112, v112
    v_exp_f32 v113, v113
    v_exp_f32 v114, v114
    v_exp_f32 v115, v115
    v_exp_f32 v116, v116
    v_exp_f32 v117, v117
    v_exp_f32 v118, v118
    v_exp_f32 v119, v119
    v_smfmac_f32_32x32x32_bf16 v[56:71], v[40:43], v[104:111], v28
    v_exp_f32 v120, v120
    v_exp_f32 v121, v121
    v_exp_f32 v122, v122
    v_smfmac_f32_32x32x32_bf16 v[56:71], v[52:55], v[112:119], v28
    v_exp_f32 v123, v123
    v_exp_f32 v124, v124
    v_exp_f32 v125, v125
    v_mfma_f32_32x32x16_bf16 v[104:119], v[172:175], v[16:19], 0
    v_exp_f32 v126, v126
    v_exp_f32 v127, v127
    v_exp_f32 v128, v128
    v_exp_f32 v129, v129
    v_exp_f32 v130, v130
    v_exp_f32 v131, v131
    v_exp_f32 v132, v132
    v_exp_f32 v133, v133
    v_exp_f32 v134, v134
    v_exp_f32 v135, v135
    v_smfmac_f32_32x32x32_bf16 v[56:71], v[48:51], v[120:127], v28
    ds_read_b128 v[168:171], v8 offset:4096
    ds_read_b128 v[172:175], v8 offset:6144
    s_mov_b64 exec, s[60:61]
    ds_read_b128 v[40:43], v8 offset:5120
    ds_read_b128 v[44:47], v8 offset:5376
    ds_read_b128 v[48:51], v8 offset:7168
    ds_read_b128 v[52:55], v8 offset:7424
    s_mov_b64 exec, -1
    s_lshl_b32 s69, s76, 17
    s_and_b32 s70, s50, 1
    s_lshl_b32 s70, s70, 13
    s_add_u32 s69, s69, s70
    s_add_u32 m0, s57, 0x1e000
    s_add_u32 s68, s69, 0x0
    buffer_load_dwordx4 v10, s[28:31], s68 offen lds
    s_add_u32 m0, s57, 0x1c000
    s_add_u32 s68, s69, 0x8000
    buffer_load_dwordx4 v10, s[28:31], s68 offen lds
    s_waitcnt lgkmcnt(0)
    s_call_b64 s[62:63], L_YA
    s_branch L_X1A
L_YA:
    s_barrier
    v_exp_f32 v104, v104
    v_exp_f32 v105, v105
    v_exp_f32 v106, v106
    v_smfmac_f32_32x32x32_bf16 v[56:71], v[44:47], v[128:135], v28
    v_exp_f32 v107, v107
    v_exp_f32 v108, v108
    v_exp_f32 v109, v109
    v_mfma_f32_32x32x16_bf16 v[120:135], v[168:171], v[16:19], 0
    v_exp_f32 v110, v110
    v_exp_f32 v111, v111
    v_exp_f32 v112, v112
    v_exp_f32 v113, v113
    v_exp_f32 v114, v114
    v_exp_f32 v115, v115
    v_exp_f32 v116, v116
    v_exp_f32 v117, v117
    v_exp_f32 v118, v118
    v_exp_f32 v119, v119
    v_smfmac_f32_32x32x32_bf16 v[56:71], v[40:43], v[104:111], v28
    v_exp_f32 v120, v120
    v_exp_f32 v121, v121
    v_exp_f32 v122, v122
    v_smfmac_f32_32x32x32_bf16 v[56:71], v[52:55], v[112:119], v28
    v_exp_f32 v123, v123
    v_exp_f32 v124, v124
    v_exp_f32 v125, v125
    v_mfma_f32_32x32x16_bf16 v[104:119], v[172:175], v[16:19], 0
    v_exp_f32 v126, v126
    v_exp_f32 v127, v127
    v_exp_f32 v128, v128
    v_exp_f32 v129, v129
    v_exp_f32 v130, v130
    v_exp_f32 v131, v131
    v_exp_f32 v132, v132
    v_exp_f32 v133, v133
    v_exp_f32 v134, v134
    v_exp_f32 v135, v135
    v_smfmac_f32_32x32x32_bf16 v[56:71], v[48:51], v[120:127], v28
    s_setpc_b64 s[62:63]
L_X1A:
    ds_read_b128 v[168:171], v8 offset:8192
    ds_read_b128 v[172:175], v8 offset:10240
    s_mov_b64 exec, s[60:61]
    ds_read_b128 v[40:43], v8 offset:9216
    ds_read_b128 v[44:47], v8 offset:9472
    ds_read_b128 v[48:51], v8 offset:11264
    ds_read_b128 v[52:55], v8 offset:11520
    s_mov_b64 exec, -1
    s_lshl_b32 s69, s76, 17
    s_and_b32 s70, s50, 1
    s_lshl_b32 s70, s70, 13
    s_add_u32 s69, s69, s70
    s_add_u32 m0, s57, 0x1a000
    s_add_u32 s68, s69, 0x10000
    buffer_load_dwordx4 v10, s[28:31], s68 offen lds
    s_add_u32 m0, s57, 0x18000
    s_add_u32 s68, s69, 0x18000
    buffer_load_dwordx4 v10, s[28:31], s68 offen lds
    s_waitcnt lgkmcnt(0)
    s_call_b64 s[62:63], L_YA
    s_waitcnt vmcnt(4)
    ds_read_b128 v[168:171], v8 offset:12288
    ds_read_b128 v[172:175], v8 offset:14336
    s_mov_b64 exec, s[60:61]
    ds_read_b128 v[40:43], v8 offset:13312
    ds_read_b128 v[44:47], v8 offset:13568
    ds_read_b128 v[48:51], v8 offset:15360
    ds_read_b128 v[52:55], v8 offset:15616
    s_mov_b64 exec, -1
    s_add_u32 m0, s57, 0x20000
    s_add_u32 s68, s57, 0x8000
    buffer_load_dwordx4 v1, s[64:67], s68 offen sc1 lds
    s_lshl_b32 s69, s76, 17
    s_and_b32 s70, s50, 1
    s_lshl_b32 s70, s70, 13
    s_add_u32 s69, s69, s70
    s_add_u32 m0, s57, 0x16000
    s_add_u32 s68, s69, 0x4000
    buffer_load_dwordx4 v10, s[28:31], s68 offen lds
    s_add_u32 m0, s57, 0x14000
    s_add_u32 s68, s69, 0xc000
    buffer_load_dwordx4 v10, s[28:31], s68 offen lds
    s_waitcnt lgkmcnt(0)
    s_call_b64 s[62:63], L_YA
    ds_read_b128 v[168:171], v8 offset:16384
    ds_read_b128 v[172:175], v8 offset:18432
    s_mov_b64 exec, s[60:61]
    ds_read_b128 v[40:43], v8 offset:17408
    ds_read_b128 v[44:47], v8 offset:17664
    ds_read_b128 v[48:51], v8 offset:19456
    ds_read_b128 v[52:55], v8 offset:19712
    s_mov_b64 exec, -1
    s_lshl_b32 s69, s76, 17
    s_and_b32 s70, s50, 1
    s_lshl_b32 s70, s70, 13
    s_add_u32 s69, s69, s70
    s_add_u32 m0, s57, 0x12000
    s_add_u32 s68, s69, 0x14000
    buffer_load_dwordx4 v10, s[28:31], s68 offen lds
    s_add_u32 m0, s57, 0x10000
    s_add_u32 s68, s69, 0x1c000
    buffer_load_dwordx4 v10, s[28:31], s68 offen lds
    s_waitcnt lgkmcnt(0)
    s_call_b64 s[62:63], L_YA
    ds_read_b128 v[168:171], v8 offset:20480
    ds_read_b128 v[172:175], v8 offset:22528
    s_mov_b64 exec, s[60:61]
    ds_read_b128 v[40:43], v8 offset:21504
    ds_read_b128 v[44:47], v8 offset:21760
    ds_read_b128 v[48:51], v8 offset:23552
    ds_read_b128 v[52:55], v8 offset:23808
    s_mov_b64 exec, -1
    s_add_u32 m0, s57, 0x22000
    s_add_u32 s68, s57, 0xa000
    buffer_load_dwordx4 v1, s[64:67], s68 offen sc1 lds
    s_add_u32 m0, s57, 0x6000
    s_add_u32 s68, s73, 0x6a000
    buffer_load_dwordx4 v10, s[24:27], s68 offen lds
    s_add_u32 m0, s57, 0x8000
    s_add_u32 s68, s73, 0x5a000
    buffer_load_dwordx4 v10, s[24:27], s68 offen lds
    s_add_u32 m0, s57, 0xa000
    s_add_u32 s68, s73, 0x60000
    buffer_load_dwordx4 v10, s[24:27], s68 offen lds
    s_waitcnt lgkmcnt(0)
    s_call_b64 s[62:63], L_YA
    s_waitcnt vmcnt(4)
    ds_read_b128 v[168:171], v8 offset:24576
    ds_read_b128 v[172:175], v8 offset:26624
    s_mov_b64 exec, s[60:61]
    ds_read_b128 v[40:43], v8 offset:25600
    ds_read_b128 v[44:47], v8 offset:25856
    ds_read_b128 v[48:51], v8 offset:27648
    ds_read_b128 v[52:55], v8 offset:27904
    s_mov_b64 exec, -1
    s_add_u32 m0, s57, 0xc000
    s_add_u32 s68, s73, 0x62000
    buffer_load_dwordx4 v10, s[24:27], s68 offen lds
    s_add_u32 m0, s57, 0xe000
    s_add_u32 s68, s73, 0x68000
    buffer_load_dwordx4 v10, s[24:27], s68 offen lds
    s_add_u32 m0, s57, 0x0
    s_add_u32 s68, s73, 0x0
    buffer_load_dwordx4 v10, s[24:27], s68 offen lds
    s_waitcnt lgkmcnt(0)
    s_call_b64 s[62:63], L_YA
    ds_read_b128 v[168:171], v8 offset:28672
    ds_read_b128 v[172:175], v8 offset:30720
    s_mov_b64 exec, s[60:61]
    ds_read_b128 v[40:43], v8 offset:29696
    ds_read_b128 v[44:47], v8 offset:29952
    ds_read_b128 v[48:51], v8 offset:31744
    ds_read_b128 v[52:55], v8 offset:32000
    s_mov_b64 exec, -1
    s_add_u32 m0, s57, 0x24000
    s_add_u32 s68, s57, 0xc000
    buffer_load_dwordx4 v1, s[64:67], s68 offen sc1 lds
    s_add_u32 m0, s57, 0x2000
    s_add_u32 s68, s73, 0x2000
    buffer_load_dwordx4 v10, s[24:27], s68 offen lds
    s_add_u32 m0, s57, 0x4000
    s_add_u32 s68, s73, 0x8000
    buffer_load_dwordx4 v10, s[24:27], s68 offen lds
    ds_read_b64_tr_b16 v[32:33], v236 offset:57344
    ds_read_b64_tr_b16 v[34:35], v236 offset:58368
    ds_read_b64_tr_b16 v[36:37], v236 offset:57856
    ds_read_b64_tr_b16 v[38:39], v236 offset:58880
    s_waitcnt lgkmcnt(0)
    s_call_b64 s[62:63], L_YA
    ds_read_b128 v[168:171], v8 offset:0
    ds_read_b128 v[172:175], v8 offset:2048
    s_mov_b64 exec, s[60:61]
    ds_read_b128 v[40:43], v8 offset:1024
    ds_read_b128 v[44:47], v8 offset:1280
    ds_read_b128 v[48:51], v8 offset:3072
    ds_read_b128 v[52:55], v8 offset:3328
    s_mov_b64 exec, -1
    s_cmp_lg_u32 s50, 0
    s_cbranch_scc1 L_hf_nol
    buffer_load_dword v14, v13, s[20:23], 0 offen sc1
L_hf_nol:
    ds_read_b64_tr_b16 v[208:209], v236 offset:49152
    ds_read_b64_tr_b16 v[210:211], v236 offset:50176
    ds_read_b64_tr_b16 v[212:213], v236 offset:49664
    ds_read_b64_tr_b16 v[214:215], v236 offset:50688
    ds_read_b64_tr_b16 v[216:217], v236 offset:40960
    ds_read_b64_tr_b16 v[218:219], v236 offset:41984
    ds_read_b64_tr_b16 v[220:221], v236 offset:41472
    ds_read_b64_tr_b16 v[222:223], v236 offset:42496
    s_waitcnt lgkmcnt(0)
    s_call_b64 s[62:63], L_YA
    s_cmp_lg_u32 s50, 0
    s_cbranch_scc1 L_hf_done
    s_mov_b32 s69, 0x4000
    s_waitcnt vmcnt(0)
L_hf_chk:
    v_cmp_ne_u32 vcc, 1, v14
    s_cbranch_vccz L_hf_done
    s_sleep 2
    buffer_load_dword v14, v13, s[20:23], 0 offen sc1
    s_sub_u32 s69, s69, 1
    s_cmp_lg_u32 s69, 0
    s_waitcnt vmcnt(0)
    s_cbranch_scc1 L_hf_chk
L_hf_done:
    s_waitcnt vmcnt(8)
    ds_read_b128 v[168:171], v8 offset:4096
    ds_read_b128 v[172:175], v8 offset:6144
    s_mov_b64 exec, s[60:61]
    ds_read_b128 v[40:43], v8 offset:5120
    ds_read_b128 v[44:47], v8 offset:5376
    ds_read_b128 v[48:51], v8 offset:7168
    ds_read_b128 v[52:55], v8 offset:7424
    s_mov_b64 exec, -1
    s_add_u32 m0, s57, 0x26000
    s_add_u32 s68, s57, 0xe000
    buffer_load_dwordx4 v1, s[64:67], s68 offen sc1 lds
    ds_read_b64_tr_b16 v[240:241], v236 offset:32768
    ds_read_b64_tr_b16 v[242:243], v236 offset:33792
    ds_read_b64_tr_b16 v[244:245], v236 offset:33280
    ds_read_b64_tr_b16 v[246:247], v236 offset:34304
    ds_read_b64_tr_b16 v[248:249], v236 offset:24576
    ds_read_b64_tr_b16 v[250:251], v236 offset:25600
    ds_read_b64_tr_b16 v[252:253], v236 offset:25088
    ds_read_b64_tr_b16 v[254:255], v236 offset:26112
    s_waitcnt lgkmcnt(0)
    s_call_b64 s[62:63], L_YA
    ds_read_b128 v[168:171], v8 offset:8192
    ds_read_b128 v[172:175], v8 offset:10240
    s_mov_b64 exec, s[60:61]
    ds_read_b128 v[40:43], v8 offset:9216
    ds_read_b128 v[44:47], v8 offset:9472
    ds_read_b128 v[48:51], v8 offset:11264
    ds_read_b128 v[52:55], v8 offset:11520
    s_mov_b64 exec, -1
    ds_read_b64_tr_b16 v[224:225], v9 offset:24576
    ds_read_b64_tr_b16 v[226:227], v9 offset:25600
    ds_read_b64_tr_b16 v[228:229], v9 offset:25088
    ds_read_b64_tr_b16 v[230:231], v9 offset:26112
    s_add_u32 s68, s72, 0x0
    buffer_load_dwordx4 v[136:139], v1, s[20:23], s68 offen sc1
    s_add_u32 s68, s72, 0x400
    buffer_load_dwordx4 v[140:143], v1, s[20:23], s68 offen sc1
    s_waitcnt lgkmcnt(0)
    s_call_b64 s[62:63], L_YA
    s_waitcnt vmcnt(5)
    ds_read_b128 v[168:171], v8 offset:12288
    ds_read_b128 v[172:175], v8 offset:14336
    s_mov_b64 exec, s[60:61]
    ds_read_b128 v[40:43], v8 offset:13312
    ds_read_b128 v[44:47], v8 offset:13568
    ds_read_b128 v[48:51], v8 offset:15360
    ds_read_b128 v[52:55], v8 offset:15616
    s_mov_b64 exec, -1
    s_add_u32 m0, s57, 0x20000
    s_add_u32 s68, s57, 0x10000
    buffer_load_dwordx4 v1, s[64:67], s68 offen sc1 lds
    s_add_u32 s68, s72, 0x800
    buffer_load_dwordx4 v[144:147], v1, s[20:23], s68 offen sc1
    s_add_u32 s72, s72, 0xc00
    s_add_u32 s73, s73, 0xa000
    s_add_u32 s74, s57, 0x12000
    s_mov_b32 s77, 4
    s_add_u32 s58, s79, 0x1000
    s_mov_b32 s81, 0x37800000
    s_mov_b32 s75, 0x3a000000
    s_waitcnt lgkmcnt(0)
    s_call_b64 s[62:63], L_YA
L_loopA:
    s_waitcnt vmcnt(3)
    ds_read_b128 v[168:171], v29 offset:0
    ds_read_b128 v[172:175], v29 offset:2048
    s_mov_b64 exec, s[60:61]
    ds_read_b128 v[40:43], v29 offset:1024
    ds_read_b128 v[44:47], v29 offset:1280
    ds_read_b128 v[48:51], v29 offset:3072
    ds_read_b128 v[52:55], v29 offset:3328
    s_mov_b64 exec, -1
    ds_read_b64_tr_b16 v[176:177], v9 offset:0
    ds_read_b64_tr_b16 v[178:179], v9 offset:1024
    ds_read_b64_tr_b16 v[180:181], v9 offset:512
    ds_read_b64_tr_b16 v[182:183], v9 offset:1536
    s_add_u32 m0, s57, 0x6000
    s_and_b32 s68, s74, 0x7fff
    buffer_load_dwordx4 v10, s[24:27], s73 offen lds
    s_add_u32 s73, s73, 0x6000
    buffer_load_dwordx4 v[148:151], v1, s[20:23], s72 offen sc1
    s_add_u32 s72, s72, 0x400
    s_waitcnt lgkmcnt(0)
    s_barrier
    v_exp_f32 v104, v104
    v_exp_f32 v105, v105
    v_exp_f32 v106, v106
    v_smfmac_f32_32x32x32_bf16 v[56:71], v[44:47], v[128:135], v28
    v_exp_f32 v107, v107
    v_exp_f32 v108, v108
    v_exp_f32 v109, v109
    v_mfma_f32_32x32x16_bf16 v[120:135], v[168:171], v[16:19], 0
    v_exp_f32 v110, v110
    v_exp_f32 v111, v111
    v_exp_f32 v112, v112
    v_exp_f32 v113, v113
    v_exp_f32 v114, v114
    v_smfmac_f32_32x32x32_bf16 v[56:71], v[40:43], v[104:111], v28
    v_exp_f32 v115, v115
    v_exp_f32 v116, v116
    v_exp_f32 v117, v117
    v_exp_f32 v118, v118
    v_exp_f32 v119, v119
    v_mfma_f32_32x32x16_bf16 v[72:87], v[176:179], v[136:139], v[72:87]
    v_exp_f32 v120, v120
    v_exp_f32 v121, v121
    v_exp_f32 v122, v122
    v_smfmac_f32_32x32x32_bf16 v[56:71], v[52:55], v[112:119], v28
    v_exp_f32 v123, v123
    v_exp_f32 v124, v124
    v_exp_f32 v125, v125
    v_mfma_f32_32x32x16_bf16 v[104:119], v[172:175], v[16:19], 0
    v_exp_f32 v126, v126
    v_exp_f32 v127, v127
    v_exp_f32 v128, v128
    v_exp_f32 v129, v129
    v_exp_f32 v130, v130
    v_smfmac_f32_32x32x32_bf16 v[56:71], v[48:51], v[120:127], v28
    v_exp_f32 v131, v131
    v_exp_f32 v132, v132
    v_exp_f32 v133, v133
    v_exp_f32 v134, v134
    v_exp_f32 v135, v135
    v_mfma_f32_32x32x16_bf16 v[88:103], v[180:183], v[136:139], v[88:103]
    s_waitcnt vmcnt(4)
    ds_read_b128 v[168:171], v29 offset:4096
    ds_read_b128 v[172:175], v29 offset:6144
    s_mov_b64 exec, s[60:61]
    ds_read_b128 v[40:43], v29 offset:5120
    ds_read_b128 v[44:47], v29 offset:5376
    ds_read_b128 v[48:51], v29 offset:7168
    ds_read_b128 v[52:55], v29 offset:7424
    s_mov_b64 exec, -1
    ds_read_b64_tr_b16 v[176:177], v9 offset:8192
    ds_read_b64_tr_b16 v[178:179], v9 offset:9216
    ds_read_b64_tr_b16 v[180:181], v9 offset:8704
    ds_read_b64_tr_b16 v[182:183], v9 offset:9728
    s_add_u32 m0, s57, 0x0
    s_and_b32 s68, s74, 0x7fff
    buffer_load_dwordx4 v10, s[24:27], s73 offen lds
    s_add_u32 s73, s73, 0x2000
    buffer_load_dwordx4 v[136:139], v1, s[20:23], s72 offen sc1
    s_add_u32 m0, s68, 0x20000
    s_add_u32 s72, s72, 0x400
    buffer_load_dwordx4 v1, s[64:67], s74 offen sc1 lds
    s_add_u32 s74, s74, 0x2000
    s_waitcnt lgkmcnt(0)
    s_barrier
    v_exp_f32 v104, v104
    v_exp_f32 v105, v105
    v_exp_f32 v106, v106
    v_smfmac_f32_32x32x32_bf16 v[56:71], v[44:47], v[128:135], v28
    v_exp_f32 v107, v107
    v_exp_f32 v108, v108
    v_exp_f32 v109, v109
    v_mfma_f32_32x32x16_bf16 v[120:135], v[168:171], v[16:19], 0
    v_exp_f32 v110, v110
    v_exp_f32 v111, v111
    v_exp_f32 v112, v112
    v_exp_f32 v113, v113
    v_exp_f32 v114, v114
    v_smfmac_f32_32x32x32_bf16 v[56:71], v[40:43], v[104:111], v28
    v_exp_f32 v115, v115
    v_exp_f32 v116, v116
    v_exp_f32 v117, v117
    v_exp_f32 v118, v118
    v_exp_f32 v119, v119
    v_mfma_f32_32x32x16_bf16 v[72:87], v[176:179], v[140:143], v[72:87]
    v_exp_f32 v120, v120
    v_exp_f32 v121, v121
    v_exp_f32 v122, v122
    v_smfmac_f32_32x32x32_bf16 v[56:71], v[52:55], v[112:119], v28
    v_exp_f32 v123, v123
    v_exp_f32 v124, v124
    v_exp_f32 v125, v125
    v_mfma_f32_32x32x16_bf16 v[104:119], v[172:175], v[16:19], 0
    v_exp_f32 v126, v126
    v_exp_f32 v127, v127
    v_exp_f32 v128, v128
    v_exp_f32 v129, v129
    v_exp_f32 v130, v130
    v_smfmac_f32_32x32x32_bf16 v[56:71], v[48:51], v[120:127], v28
    v_exp_f32 v131, v131
    v_exp_f32 v132, v132
    v_exp_f32 v133, v133
    v_exp_f32 v134, v134
    v_exp_f32 v135, v135
    v_mfma_f32_32x32x16_bf16 v[88:103], v[180:183], v[140:143], v[88:103]
    s_waitcnt vmcnt(4)
    ds_read_b128 v[168:171], v29 offset:8192
    ds_read_b128 v[172:175], v29 offset:10240
    s_mov_b64 exec, s[60:61]
    ds_read_b128 v[40:43], v29 offset:9216
    ds_read_b128 v[44:47], v29 offset:9472
    ds_read_b128 v[48:51], v29 offset:11264
    ds_read_b128 v[52:55], v29 offset:11520
    s_mov_b64 exec, -1
    ds_read_b64_tr_b16 v[176:177], v9 offset:16384
    ds_read_b64_tr_b16 v[178:179], v9 offset:17408
    ds_read_b64_tr_b16 v[180:181], v9 offset:16896
    ds_read_b64_tr_b16 v[182:183], v9 offset:17920
    s_add_u32 m0, s57, 0x2000
    s_and_b32 s68, s74, 0x7fff
    buffer_load_dwordx4 v10, s[24:27], s73 offen lds
    s_add_u32 s73, s73, 0x6000
    buffer_load_dwordx4 v[140:143], v1, s[20:23], s72 offen sc1
    s_add_u32 s72, s72, 0x400
    s_waitcnt lgkmcnt(0)
    s_barrier
    v_exp_f32 v104, v104
    v_exp_f32 v105, v105
    v_exp_f32 v106, v106
    v_smfmac_f32_32x32x32_bf16 v[56:71], v[44:47], v[128:135], v28
    v_exp_f32 v107, v107
    v_exp_f32 v108, v108
    v_exp_f32 v109, v109
    v_mfma_f32_32x32x16_bf16 v[120:135], v[168:171], v[16:19], 0
    v_exp_f32 v110, v110
    v_exp_f32 v111, v111
    v_exp_f32 v112, v112
    v_exp_f32 v113, v113
    v_exp_f32 v114, v114
    v_smfmac_f32_32x32x32_bf16 v[56:71], v[40:43], v[104:111], v28
    v_exp_f32 v115, v115
    v_exp_f32 v116, v116
    v_exp_f32 v117, v117
    v_exp_f32 v118, v118
    v_exp_f32 v119, v119
    v_mfma_f32_32x32x16_bf16 v[72:87], v[176:179], v[144:147], v[72:87]
    v_exp_f32 v120, v120
    v_exp_f32 v121, v121
    v_exp_f32 v122, v122
    v_smfmac_f32_32x32x32_bf16 v[56:71], v[52:55], v[112:119], v28
    v_exp_f32 v123, v123
    v_exp_f32 v124, v124
    v_exp_f32 v125, v125
    v_mfma_f32_32x32x16_bf16 v[104:119], v[172:175], v[16:19], 0
    v_exp_f32 v126, v126
    v_exp_f32 v127, v127
    v_exp_f32 v128, v128
    v_exp_f32 v129, v129
    v_exp_f32 v130, v130
    v_smfmac_f32_32x32x32_bf16 v[56:71], v[48:51], v[120:127], v28
    v_exp_f32 v131, v131
    v_exp_f32 v132, v132
    v_exp_f32 v133, v133
    v_exp_f32 v134, v134
    v_exp_f32 v135, v135
    v_mfma_f32_32x32x16_bf16 v[88:103], v[180:183], v[144:147], v[88:103]
    s_waitcnt vmcnt(4)
    ds_read_b128 v[168:171], v29 offset:12288
    ds_read_b128 v[172:175], v29 offset:14336
    s_mov_b64 exec, s[60:61]
    ds_read_b128 v[40:43], v29 offset:13312
    ds_read_b128 v[44:47], v29 offset:13568
    ds_read_b128 v[48:51], v29 offset:15360
    ds_read_b128 v[52:55], v29 offset:15616
    s_mov_b64 exec, -1
    ds_read_b64_tr_b16 v[176:177], v9 offset:24576
    ds_read_b64_tr_b16 v[178:179], v9 offset:25600
    ds_read_b64_tr_b16 v[180:181], v9 offset:25088
    ds_read_b64_tr_b16 v[182:183], v9 offset:26112
    s_add_u32 m0, s57, 0x4000
    s_and_b32 s68, s74, 0x7fff
    buffer_load_dwordx4 v10, s[24:27], s73 offen lds
    s_add_u32 s73, s73, 0x2000
    buffer_load_dwordx4 v[144:147], v1, s[20:23], s72 offen sc1
    s_add_u32 m0, s68, 0x20000
    s_add_u32 s72, s72, 0x400
    buffer_load_dwordx4 v1, s[64:67], s74 offen sc1 lds
    s_add_u32 s74, s74, 0x2000
    s_sub_u32 s77, s77, 1
    s_cmp_lg_u32 s77, 0
    s_waitcnt lgkmcnt(0)
    s_barrier
    v_exp_f32 v104, v104
    v_exp_f32 v105, v105
    v_exp_f32 v106, v106
    v_smfmac_f32_32x32x32_bf16 v[56:71], v[44:47], v[128:135], v28
    v_exp_f32 v107, v107
    v_exp_f32 v108, v108
    v_exp_f32 v109, v109
    v_mfma_f32_32x32x16_bf16 v[120:135], v[168:171], v[16:19], 0
    v_exp_f32 v110, v110
    v_exp_f32 v111, v111
    v_exp_f32 v112, v112
    v_exp_f32 v113, v113
    v_exp_f32 v114, v114
    v_smfmac_f32_32x32x32_bf16 v[56:71], v[40:43], v[104:111], v28
    v_exp_f32 v115, v115
    v_exp_f32 v116, v116
    v_exp_f32 v117, v117
    v_exp_f32 v118, v118
    v_exp_f32 v119, v119
    v_mfma_f32_32x32x16_bf16 v[72:87], v[176:179], v[148:151], v[72:87]
    v_exp_f32 v120, v120
    v_exp_f32 v121, v121
    v_exp_f32 v122, v122
    v_smfmac_f32_32x32x32_bf16 v[56:71], v[52:55], v[112:119], v28
    v_exp_f32 v123, v123
    v_exp_f32 v124, v124
    v_exp_f32 v125, v125
    v_mfma_f32_32x32x16_bf16 v[104:119], v[172:175], v[16:19], 0
    v_exp_f32 v126, v126
    v_exp_f32 v127, v127
    v_exp_f32 v128, v128
    v_exp_f32 v129, v129
    v_exp_f32 v130, v130
    v_smfmac_f32_32x32x32_bf16 v[56:71], v[48:51], v[120:127], v28
    v_exp_f32 v131, v131
    v_exp_f32 v132, v132
    v_xor_b32 v29, 0x4000, v29
    v_exp_f32 v133, v133
    v_exp_f32 v134, v134
    v_exp_f32 v135, v135
    v_mfma_f32_32x32x16_bf16 v[88:103], v[180:183], v[148:151], v[88:103]
    s_cbranch_scc1 L_loopA
    s_waitcnt vmcnt(4)
    ds_read_b128 v[168:171], v29 offset:0
    ds_read_b128 v[172:175], v29 offset:2048
    s_mov_b64 exec, s[60:61]
    ds_read_b128 v[40:43], v29 offset:1024
    ds_read_b128 v[44:47], v29 offset:1280
    ds_read_b128 v[48:51], v29 offset:3072
    ds_read_b128 v[52:55], v29 offset:3328
    s_mov_b64 exec, -1
    ds_read_b64_tr_b16 v[176:177], v9 offset:0
    ds_read_b64_tr_b16 v[178:179], v9 offset:1024
    ds_read_b64_tr_b16 v[180:181], v9 offset:512
    ds_read_b64_tr_b16 v[182:183], v9 offset:1536
    s_add_u32 m0, s57, 0x6000
    s_and_b32 s68, s74, 0x7fff
    buffer_load_dwordx4 v10, s[24:27], s73 offen lds
    s_add_u32 s73, s73, 0x6000
    buffer_load_dwordx4 v[148:151], v1, s[20:23], s72 offen sc1
    s_add_u32 s72, s72, 0x400
    s_add_u32 s68, s72, 0x1c00
    buffer_load_dwordx4 v[232:235], v1, s[20:23], s68 offen sc1
    s_add_u32 s68, s72, 0xc00
    buffer_load_dwordx4 v[152:155], v1, s[20:23], s68 offen sc1
    s_waitcnt lgkmcnt(0)
    s_barrier
    v_exp_f32 v104, v104
    v_exp_f32 v105, v105
    v_exp_f32 v106, v106
    v_smfmac_f32_32x32x32_bf16 v[56:71], v[44:47], v[128:135], v28
    v_exp_f32 v107, v107
    v_exp_f32 v108, v108
    v_exp_f32 v109, v109
    v_mfma_f32_32x32x16_bf16 v[120:135], v[168:171], v[16:19], 0
    v_exp_f32 v110, v110
    v_exp_f32 v111, v111
    v_exp_f32 v112, v112
    v_exp_f32 v113, v113
    v_exp_f32 v114, v114
    v_smfmac_f32_32x32x32_bf16 v[56:71], v[40:43], v[104:111], v28
    v_exp_f32 v115, v115
    v_exp_f32 v116, v116
    v_exp_f32 v117, v117
    v_exp_f32 v118, v118
    v_exp_f32 v119, v119
    v_mfma_f32_32x32x16_bf16 v[72:87], v[176:179], v[136:139], v[72:87]
    v_exp_f32 v120, v120
    v_exp_f32 v121, v121
    v_exp_f32 v122, v122
    v_smfmac_f32_32x32x32_bf16 v[56:71], v[52:55], v[112:119], v28
    v_exp_f32 v123, v123
    v_exp_f32 v124, v124
    v_exp_f32 v125, v125
    v_mfma_f32_32x32x16_bf16 v[104:119], v[172:175], v[16:19], 0
    v_exp_f32 v126, v126
    v_exp_f32 v127, v127
    v_exp_f32 v128, v128
    v_exp_f32 v129, v129
    v_exp_f32 v130, v130
    v_smfmac_f32_32x32x32_bf16 v[56:71], v[48:51], v[120:127], v28
    v_exp_f32 v131, v131
    v_exp_f32 v132, v132
    v_exp_f32 v133, v133
    v_exp_f32 v134, v134
    v_exp_f32 v135, v135
    v_mfma_f32_32x32x16_bf16 v[88:103], v[180:183], v[136:139], v[88:103]
    s_waitcnt vmcnt(6)
    ds_read_b128 v[168:171], v29 offset:4096
    ds_read_b128 v[172:175], v29 offset:6144
    s_mov_b64 exec, s[60:61]
    ds_read_b128 v[40:43], v29 offset:5120
    ds_read_b128 v[44:47], v29 offset:5376
    ds_read_b128 v[48:51], v29 offset:7168
    ds_read_b128 v[52:55], v29 offset:7424
    s_mov_b64 exec, -1
    ds_read_b64_tr_b16 v[176:177], v9 offset:8192
    ds_read_b64_tr_b16 v[178:179], v9 offset:9216
    ds_read_b64_tr_b16 v[180:181], v9 offset:8704
    ds_read_b64_tr_b16 v[182:183], v9 offset:9728
    s_add_u32 m0, s57, 0x0
    s_and_b32 s68, s74, 0x7fff
    buffer_load_dwordx4 v10, s[24:27], s73 offen lds
    s_add_u32 s73, s73, 0x2000
    buffer_load_dwordx4 v[136:139], v1, s[20:23], s72 offen sc1
    s_add_u32 s72, s72, 0x400
    s_add_u32 s68, s72, 0xc00
    buffer_load_dwordx4 v[156:159], v1, s[20:23], s68 offen sc1
    s_add_u32 s68, s72, 0x1000
    buffer_load_dwordx4 v[160:163], v1, s[20:23], s68 offen sc1
    s_waitcnt lgkmcnt(0)
    s_barrier
    v_exp_f32 v104, v104
    v_exp_f32 v105, v105
    v_exp_f32 v106, v106
    v_smfmac_f32_32x32x32_bf16 v[56:71], v[44:47], v[128:135], v28
    v_exp_f32 v107, v107
    v_exp_f32 v108, v108
    v_exp_f32 v109, v109
    v_mfma_f32_32x32x16_bf16 v[120:135], v[168:171], v[16:19], 0
    v_exp_f32 v110, v110
    v_exp_f32 v111, v111
    v_exp_f32 v112, v112
    v_exp_f32 v113, v113
    v_exp_f32 v114, v114
    v_smfmac_f32_32x32x32_bf16 v[56:71], v[40:43], v[104:111], v28
    v_exp_f32 v115, v115
    v_exp_f32 v116, v116
    v_exp_f32 v117, v117
    v_exp_f32 v118, v118
    v_exp_f32 v119, v119
    v_mfma_f32_32x32x16_bf16 v[72:87], v[176:179], v[140:143], v[72:87]
    v_exp_f32 v120, v120
    v_exp_f32 v121, v121
    v_exp_f32 v122, v122
    v_smfmac_f32_32x32x32_bf16 v[56:71], v[52:55], v[112:119], v28
    v_exp_f32 v123, v123
    v_exp_f32 v124, v124
    v_exp_f32 v125, v125
    v_mfma_f32_32x32x16_bf16 v[104:119], v[172:175], v[16:19], 0
    v_exp_f32 v126, v126
    v_exp_f32 v127, v127
    v_exp_f32 v128, v128
    v_exp_f32 v129, v129
    v_exp_f32 v130, v130
    v_smfmac_f32_32x32x32_bf16 v[56:71], v[48:51], v[120:127], v28
    v_exp_f32 v131, v131
    v_exp_f32 v132, v132
    v_exp_f32 v133, v133
    v_exp_f32 v134, v134
    v_exp_f32 v135, v135
    v_mfma_f32_32x32x16_bf16 v[88:103], v[180:183], v[140:143], v[88:103]
    s_waitcnt vmcnt(7)
    ds_read_b128 v[168:171], v29 offset:8192
    ds_read_b128 v[172:175], v29 offset:10240
    s_mov_b64 exec, s[60:61]
    ds_read_b128 v[40:43], v29 offset:9216
    ds_read_b128 v[44:47], v29 offset:9472
    ds_read_b128 v[48:51], v29 offset:11264
    ds_read_b128 v[52:55], v29 offset:11520
    s_mov_b64 exec, -1
    ds_read_b64_tr_b16 v[176:177], v9 offset:16384
    ds_read_b64_tr_b16 v[178:179], v9 offset:17408
    ds_read_b64_tr_b16 v[180:181], v9 offset:16896
    ds_read_b64_tr_b16 v[182:183], v9 offset:17920
    s_add_u32 m0, s57, 0x2000
    s_and_b32 s68, s74, 0x7fff
    buffer_load_dwordx4 v10, s[24:27], s73 offen lds
    s_add_u32 s73, s73, 0x6000
    buffer_load_dwordx4 v[140:143], v1, s[20:23], s72 offen sc1
    s_add_u32 s72, s72, 0x400
    s_add_u32 s68, s72, 0x1000
    buffer_load_dwordx4 v[164:167], v1, s[20:23], s68 offen sc1
    s_waitcnt lgkmcnt(0)
    s_barrier
    v_exp_f32 v104, v104
    v_exp_f32 v105, v105
    v_exp_f32 v106, v106
    v_smfmac_f32_32x32x32_bf16 v[56:71], v[44:47], v[128:135], v28
    v_exp_f32 v107, v107
    v_exp_f32 v108, v108
    v_exp_f32 v109, v109
    v_mfma_f32_32x32x16_bf16 v[120:135], v[168:171], v[16:19], 0
    v_exp_f32 v110, v110
    v_exp_f32 v111, v111
    v_exp_f32 v112, v112
    v_exp_f32 v113, v113
    v_exp_f32 v114, v114
    v_smfmac_f32_32x32x32_bf16 v[56:71], v[40:43], v[104:111], v28
    v_exp_f32 v115, v115
    v_exp_f32 v116, v116
    v_exp_f32 v117, v117
    v_exp_f32 v118, v118
    v_exp_f32 v119, v119
    v_mfma_f32_32x32x16_bf16 v[72:87], v[176:179], v[144:147], v[72:87]
    v_exp_f32 v120, v120
    v_exp_f32 v121, v121
    v_exp_f32 v122, v122
    v_smfmac_f32_32x32x32_bf16 v[56:71], v[52:55], v[112:119], v28
    v_exp_f32 v123, v123
    v_exp_f32 v124, v124
    v_exp_f32 v125, v125
    v_mfma_f32_32x32x16_bf16 v[104:119], v[172:175], v[16:19], 0
    v_exp_f32 v126, v126
    v_exp_f32 v127, v127
    v_exp_f32 v128, v128
    v_exp_f32 v129, v129
    v_exp_f32 v130, v130
    v_smfmac_f32_32x32x32_bf16 v[56:71], v[48:51], v[120:127], v28
    v_exp_f32 v131, v131
    v_exp_f32 v132, v132
    v_exp_f32 v133, v133
    v_exp_f32 v134, v134
    v_exp_f32 v135, v135
    v_mfma_f32_32x32x16_bf16 v[88:103], v[180:183], v[144:147], v[88:103]
    s_waitcnt vmcnt(6)
    ds_read_b128 v[168:171], v29 offset:12288
    s_mov_b64 exec, s[60:61]
    ds_read_b128 v[40:43], v29 offset:13312
    ds_read_b128 v[44:47], v29 offset:13568
    ds_read_b128 v[48:51], v29 offset:15360
    ds_read_b128 v[52:55], v29 offset:15616
    s_mov_b64 exec, -1
    ds_read_b64_tr_b16 v[176:177], v9 offset:24576
    ds_read_b64_tr_b16 v[178:179], v9 offset:25600
    ds_read_b64_tr_b16 v[180:181], v9 offset:25088
    ds_read_b64_tr_b16 v[182:183], v9 offset:26112
    ds_read_b64_tr_b16 v[184:185], v9 offset:32768
    ds_read_b64_tr_b16 v[186:187], v9 offset:33792
    ds_read_b64_tr_b16 v[188:189], v9 offset:33280
    ds_read_b64_tr_b16 v[190:191], v9 offset:34304
    s_add_u32 m0, s57, 0x4000
    s_and_b32 s68, s74, 0x7fff
    buffer_load_dwordx4 v10, s[24:27], s73 offen lds
    s_add_u32 s73, s73, 0x2000
    buffer_load_dwordx4 v[144:147], v1, s[20:23], s72 offen sc1
    s_add_u32 s72, s72, 0x400
    s_waitcnt lgkmcnt(0)
    s_barrier
    v_exp_f32 v104, v104
    v_exp_f32 v105, v105
    v_exp_f32 v106, v106
    v_smfmac_f32_32x32x32_bf16 v[56:71], v[44:47], v[128:135], v28
    v_exp_f32 v107, v107
    v_exp_f32 v108, v108
    v_exp_f32 v109, v109
    v_mfma_f32_32x32x16_bf16 v[120:135], v[168:171], v[16:19], 0
    v_exp_f32 v110, v110
    v_exp_f32 v111, v111
    v_exp_f32 v112, v112
    v_exp_f32 v113, v113
    v_exp_f32 v114, v114
    v_exp_f32 v115, v115
    v_exp_f32 v116, v116
    v_exp_f32 v117, v117
    v_exp_f32 v118, v118
    v_exp_f32 v119, v119
    v_smfmac_f32_32x32x32_bf16 v[56:71], v[40:43], v[104:111], v28
    v_exp_f32 v120, v120
    v_exp_f32 v121, v121
    v_exp_f32 v122, v122
    v_smfmac_f32_32x32x32_bf16 v[56:71], v[52:55], v[112:119], v28
    v_exp_f32 v123, v123
    v_exp_f32 v124, v124
    v_exp_f32 v125, v125
    v_exp_f32 v126, v126
    v_exp_f32 v127, v127
    v_exp_f32 v128, v128
    v_exp_f32 v129, v129
    v_exp_f32 v130, v130
    v_smfmac_f32_32x32x32_bf16 v[56:71], v[48:51], v[120:127], v28
    v_exp_f32 v131, v131
    v_exp_f32 v132, v132
    v_exp_f32 v133, v133
    v_exp_f32 v134, v134
    v_exp_f32 v135, v135
    s_nop 1
    v_smfmac_f32_32x32x32_bf16 v[56:71], v[24:27], v[128:135], v28
    s_setprio 0
    s_cmp_eq_u32 s51, 0
    s_nop 9
    v_rcp_f32 v4, v64
    s_nop 0
    v_mul_f32_e64 v4, v4, v6
    v_mul_f32 v56, v4, v56
    v_mul_f32 v57, v4, v57
    v_mul_f32 v58, v4, v58
    v_mul_f32 v59, v4, v59
    v_mul_f32 v60, v4, v60
    v_mul_f32 v61, v4, v61
    v_mul_f32 v62, v4, v62
    v_mul_f32 v63, v4, v63
    v_fmac_f32 v64, 0, v56
    v_cvt_pk_bf16_f32 v20, v56, v57
    v_fmac_f32 v64, 0, v57
    v_fmac_f32 v64, 0, v58
    v_cvt_pk_bf16_f32 v21, v58, v59
    v_fmac_f32 v64, 0, v59
    v_fmac_f32 v64, 0, v60
    v_cvt_pk_bf16_f32 v22, v60, v61
    v_fmac_f32 v64, 0, v61
    v_fmac_f32 v64, 0, v62
    v_cvt_pk_bf16_f32 v23, v62, v63
    v_fmac_f32 v64, 0, v63
    v_subrev_u32 v64, s81, v64
    v_cmp_lt_u32 vcc, s75, v64
    s_cbranch_vccnz L_fb
L_fbretA:
    buffer_store_dwordx4 v[20:23], v1, s[20:23], s78 offen sc1
    s_waitcnt vmcnt(1)
    s_barrier
    buffer_load_dwordx4 v[104:107], v1, s[20:23], s79 offen offset:0 sc1
    buffer_load_dwordx4 v[108:111], v1, s[20:23], s79 offen offset:2048 sc1
    buffer_load_dwordx4 v[112:115], v1, s[20:23], s58 offen offset:0 sc1
    buffer_load_dwordx4 v[116:119], v1, s[20:23], s58 offen offset:2048 sc1
    buffer_load_dwordx4 v[120:123], v1, s[20:23], s79 offen offset:1024 sc1
    buffer_load_dwordx4 v[124:127], v1, s[20:23], s79 offen offset:3072 sc1
    ds_read_b64_tr_b16 v[40:41], v236 offset:16384
    ds_read_b64_tr_b16 v[42:43], v236 offset:17408
    ds_read_b64_tr_b16 v[44:45], v236 offset:16896
    ds_read_b64_tr_b16 v[46:47], v236 offset:17920
    buffer_load_dwordx4 v[128:131], v1, s[20:23], s58 offen offset:1024 sc1
    ds_read_b64_tr_b16 v[48:49], v236 offset:8192
    ds_read_b64_tr_b16 v[50:51], v236 offset:9216
    ds_read_b64_tr_b16 v[52:53], v236 offset:8704
    ds_read_b64_tr_b16 v[54:55], v236 offset:9728
    buffer_load_dwordx4 v[132:135], v1, s[20:23], s58 offen offset:3072 sc1
    ds_read_b64_tr_b16 v[56:57], v236 offset:0
    ds_read_b64_tr_b16 v[58:59], v236 offset:1024
    ds_read_b64_tr_b16 v[60:61], v236 offset:512
    ds_read_b64_tr_b16 v[62:63], v236 offset:1536
    s_branch L_tl2
L_light:
    s_add_u32 s54, s69, 14
    s_waitcnt lgkmcnt(0)
    s_load_dwordx2 s[40:41], s[0:1], 16
    s_load_dwordx2 s[72:73], s[0:1], 24
    s_load_dwordx2 s[44:45], s[0:1], 72
    s_load_dwordx2 s[28:29], s[0:1], 32
    s_mov_b32 s42, 0x4000
    s_mov_b32 s43, 0x20000
    s_mov_b32 s74, 0x4000
    s_mov_b32 s75, 0x20000
    s_mov_b32 s46, 0x400
    s_mov_b32 s47, 0x20000
    s_mov_b32 s6, 0x200000
    s_mov_b32 s7, 0x20000
    v_lshrrev_b32 v2, 4, v0
    v_xor_b32 v2, v2, v0
    v_and_b32 v2, 7, v2
    s_lshl_b32 s68, s53, 17
    v_lshl_add_u32 v2, v2, 4, s68
    v_lshrrev_b32 v3, 3, v0
    v_lshl_add_u32 v249, v3, 10, v2
    v_and_b32 v2, 63, v0
    v_lshlrev_b32 v1, 4, v2
    s_sub_u32 s77, s54, 14
    s_lshl_b32 s79, s77, 16
    s_lshl_b32 s80, s77, 13
    s_add_u32 s58, s80, s57
    s_xor_b32 s80, s80, 0x2000
    s_add_u32 s68, s57, 0x2000
    s_waitcnt lgkmcnt(0)
    s_add_u32 m0, s57, 0x20000
    s_nop 0
    buffer_load_dwordx4 v1, s[40:43], s57 offen lds
    s_add_u32 m0, s57, 0x24000
    s_nop 0
    buffer_load_dwordx4 v1, s[72:75], s57 offen lds
    s_mov_b32 m0, s80
    s_nop 0
    buffer_load_dwordx4 v1, s[44:47], 0 offen lds
    s_add_u32 m0, s58, 0x0
    s_nop 0
    buffer_load_dwordx4 v249, s[4:7], s79 offen offset:0 lds
    s_add_u32 m0, s58, 0x3f80
    s_nop 0
    buffer_load_dwordx4 v249, s[4:7], s79 offen offset:128 lds
    s_barrier
    s_add_u32 m0, s58, 0x7f00
    s_nop 0
    buffer_load_dwordx4 v249, s[4:7], s79 offen offset:256 lds
    s_add_u32 m0, s58, 0xbe80
    s_nop 0
    buffer_load_dwordx4 v249, s[4:7], s79 offen offset:384 lds
    s_barrier
    s_add_u32 m0, s57, 0x22000
    s_nop 0
    buffer_load_dwordx4 v1, s[40:43], s68 offen lds
    s_add_u32 m0, s57, 0x26000
    s_nop 0
    buffer_load_dwordx4 v1, s[72:75], s68 offen lds
    s_add_u32 m0, s58, 0xfe00
    s_nop 0
    buffer_load_dwordx4 v249, s[4:7], s79 offen offset:512 lds
    s_add_u32 m0, s58, 0x13d80
    s_nop 0
    buffer_load_dwordx4 v249, s[4:7], s79 offen offset:640 lds
    s_barrier
    s_add_u32 m0, s58, 0x17d00
    s_nop 0
    buffer_load_dwordx4 v249, s[4:7], s79 offen offset:768 lds
    s_add_u32 m0, s58, 0x1bc80
    s_nop 0
    buffer_load_dwordx4 v249, s[4:7], s79 offen offset:896 lds
    s_mov_b64 s[64:65], s[20:21]
    s_mov_b64 s[24:25], s[32:33]
    s_mov_b64 s[32:33], s[36:37]
    s_mov_b64 s[36:37], s[38:39]
    v_and_b32 v0, 63, v0
    v_lshlrev_b32 v1, 4, v0
    s_and_b32 s68, s2, 7
    s_xor_b32 s68, s68, 4
    s_bfe_u32 s69, s2, 0x20003
    s_lshl2_add_u32 s55, s68, s69
    s_lshr_b32 s56, s2, 5
    s_mov_b32 s18, 0x80000
    s_mov_b32 s19, 0x20000
    s_lshr_b32 s51, s50, 2
    s_and_b32 s52, s50, 3
    v_and_b32 v2, 15, v0
    v_lshrrev_b32 v3, 4, v0
    v_bfe_u32 v4, v0, 1, 3
    v_xor_b32 v4, v4, v3
    v_lshlrev_b32 v4, 4, v4
    v_lshl_add_u32 v240, v2, 7, v4
    v_bfe_u32 v2, v0, 2, 2
    v_and_b32 v4, 3, v0
    v_lshl_add_u32 v248, v3, 3, v2
    v_lshlrev_b32 v248, 6, v248
    v_xor_b32 v5, s51, v3
    v_and_b32 v5, 1, v5
    v_lshl_add_u32 v248, v5, 5, v248
    v_lshl_add_u32 v248, v4, 3, v248
    v_lshrrev_b32 v3, 5, v0
    v_bfrev_b32 v5, v4
    v_lshrrev_b32 v5, 30, v5
    s_cmp_ge_u32 s52, 2
    s_cselect_b64 vcc, -1, 0
    v_cndmask_b32 v4, v5, v4, vcc
    v_lshl_add_u32 v244, v3, 3, v2
    v_lshlrev_b32 v244, 5, v244
    v_lshl_add_u32 v244, v4, 3, v244
    s_lshr_b32 s68, s52, 1
    s_lshl_b32 s68, s68, 14
    s_add_u32 s68, s68, 0x20000
    v_add_u32 v244, s68, v244
    v_lshl_add_u32 v245, v3, 4, s80
    s_and_b32 s68, s52, 1
    s_lshl_b32 s69, s77, 1
    s_add_u32 s77, s68, s69
    s_lshl_b32 s68, s77, 12
    v_and_b32 v2, 31, v0
    v_lshrrev_b32 v4, 1, v0
    v_lshlrev_b32 v5, 1, v0
    v_bfi_b32 v4, 4, v4, v5
    v_bfi_b32 v4, 12, v4, v2
    v_cndmask_b32 v2, v2, v4, vcc
    v_bfe_u32 v4, v2, 1, 3
    v_xor_b32 v4, v4, v3
    v_lshlrev_b32 v4, 4, v4
    v_lshl_add_u32 v4, v2, 7, v4
    v_add_u32 v224, s68, v4
    v_xor_b32 v225, 32, v224
    v_xor_b32 v226, 64, v224
    v_xor_b32 v227, 96, v224
    v_add_u32 v228, 0x10000, v224
    v_add_u32 v229, 0x10000, v225
    v_add_u32 v230, 0x10000, v226
    v_add_u32 v231, 0x10000, v227
    s_waitcnt lgkmcnt(0)
    s_mov_b32 s22, 0x1000000
    s_mov_b32 s23, 0x20000
    s_mov_b32 s66, 0x20000
    s_mov_b32 s67, 0x20000
    s_mov_b32 s38, 0x100
    s_mov_b32 s39, 0x20000
    s_mov_b32 s60, 0xffff
    s_mov_b32 s61, 0xffff
    s_lshl_b32 s68, s53, 2
    s_add_u32 s68, s68, s52
    s_lshl_b32 s69, s68, 5
    s_lshl_b32 s70, s81, 1
    s_add_u32 s69, s69, s70
    s_add_u32 s69, s69, s51
    s_lshl_b32 s69, s69, 10
    s_add_u32 s78, s69, 0x100000
    v_mov_b32 v16, -1
    v_mov_b32 v17, -1
    v_mov_b32 v18, -1
    v_mov_b32 v19, -1
    buffer_store_dwordx4 v[16:19], v1, s[20:23], s78 offen sc1
    v_mov_b32 v11, 1
    v_mov_b32 v12, 0
    v_and_b32 v15, 31, v0
    v_lshlrev_b32 v15, 2, v15
    s_cmp_lg_u32 s51, 0
    s_cbranch_scc1 L_lB
    s_not_b64 s[48:49], s[60:61]
    s_cmp_ge_u32 s52, 2
    s_cbranch_scc1 L_lV
    s_waitcnt vmcnt(9)
    s_barrier
    ds_read_b128 v[184:187], v224 offset:0
    ds_read_b64_tr_b16 v[188:189], v244 offset:0
    ds_read_b64_tr_b16 v[190:191], v244 offset:128
    s_mov_b64 exec, s[48:49]
    ds_read_b128 v[188:191], v245 offset:0
    s_mov_b64 exec, -1
    ds_read_b128 v[192:195], v225 offset:0
    ds_read_b64_tr_b16 v[196:197], v244 offset:512
    ds_read_b64_tr_b16 v[198:199], v244 offset:640
    s_mov_b64 exec, s[48:49]
    ds_read_b128 v[196:199], v245 offset:32
    s_mov_b64 exec, -1
    ds_read_b128 v[200:203], v226 offset:0
    ds_read_b64_tr_b16 v[204:205], v244 offset:1024
    ds_read_b64_tr_b16 v[206:207], v244 offset:1152
    s_mov_b64 exec, s[48:49]
    ds_read_b128 v[204:207], v245 offset:64
    s_mov_b64 exec, -1
    s_waitcnt lgkmcnt(8)
    v_mfma_f32_32x32x16_bf16 v[104:119], v[188:191], v[184:187], 0
    ds_read_b128 v[208:211], v227 offset:0
    ds_read_b64_tr_b16 v[212:213], v244 offset:1536
    ds_read_b64_tr_b16 v[214:215], v244 offset:1664
    s_mov_b64 exec, s[48:49]
    ds_read_b128 v[212:215], v245 offset:96
    s_mov_b64 exec, -1
    s_waitcnt lgkmcnt(8)
    v_mfma_f32_32x32x16_bf16 v[104:119], v[196:199], v[192:195], v[104:119]
    ds_read_b128 v[184:187], v224 offset:16384
    ds_read_b64_tr_b16 v[188:189], v244 offset:2048
    ds_read_b64_tr_b16 v[190:191], v244 offset:2176
    s_mov_b64 exec, s[48:49]
    ds_read_b128 v[188:191], v245 offset:128
    s_mov_b64 exec, -1
    s_waitcnt lgkmcnt(8)
    v_mfma_f32_32x32x16_bf16 v[104:119], v[204:207], v[200:203], v[104:119]
    ds_read_b128 v[192:195], v225 offset:16384
    ds_read_b64_tr_b16 v[196:197], v244 offset:2560
    ds_read_b64_tr_b16 v[198:199], v244 offset:2688
    s_mov_b64 exec, s[48:49]
    ds_read_b128 v[196:199], v245 offset:160
    s_mov_b64 exec, -1
    s_waitcnt lgkmcnt(8)
    v_mfma_f32_32x32x16_bf16 v[104:119], v[212:215], v[208:211], v[104:119]
    ds_read_b128 v[200:203], v226 offset:16384
    ds_read_b64_tr_b16 v[204:205], v244 offset:3072
    ds_read_b64_tr_b16 v[206:207], v244 offset:3200
    s_mov_b64 exec, s[48:49]
    ds_read_b128 v[204:207], v245 offset:192
    s_mov_b64 exec, -1
    s_waitcnt lgkmcnt(8)
    v_mfma_f32_32x32x16_bf16 v[104:119], v[188:191], v[184:187], v[104:119]
    ds_read_b128 v[208:211], v227 offset:16384
    ds_read_b64_tr_b16 v[212:213], v244 offset:3584
    ds_read_b64_tr_b16 v[214:215], v244 offset:3712
    s_mov_b64 exec, s[48:49]
    ds_read_b128 v[212:215], v245 offset:224
    s_mov_b64 exec, -1
    s_waitcnt lgkmcnt(8)
    v_mfma_f32_32x32x16_bf16 v[104:119], v[196:199], v[192:195], v[104:119]
    s_waitcnt lgkmcnt(4)
    v_mfma_f32_32x32x16_bf16 v[104:119], v[204:207], v[200:203], v[104:119]
    s_waitcnt lgkmcnt(0)
    v_mfma_f32_32x32x16_bf16 v[104:119], v[212:215], v[208:211], v[104:119]
    s_waitcnt vmcnt(7)
    s_barrier
    ds_read_b128 v[184:187], v224 offset:32768
    ds_read_b64_tr_b16 v[188:189], v244 offset:4096
    ds_read_b64_tr_b16 v[190:191], v244 offset:4224
    s_mov_b64 exec, s[48:49]
    ds_read_b128 v[188:191], v245 offset:256
    s_mov_b64 exec, -1
    ds_read_b128 v[192:195], v225 offset:32768
    ds_read_b64_tr_b16 v[196:197], v244 offset:4608
    ds_read_b64_tr_b16 v[198:199], v244 offset:4736
    s_mov_b64 exec, s[48:49]
    ds_read_b128 v[196:199], v245 offset:288
    s_mov_b64 exec, -1
    ds_read_b128 v[200:203], v226 offset:32768
    ds_read_b64_tr_b16 v[204:205], v244 offset:5120
    ds_read_b64_tr_b16 v[206:207], v244 offset:5248
    s_mov_b64 exec, s[48:49]
    ds_read_b128 v[204:207], v245 offset:320
    s_mov_b64 exec, -1
    s_waitcnt lgkmcnt(8)
    v_mfma_f32_32x32x16_bf16 v[104:119], v[188:191], v[184:187], v[104:119]
    ds_read_b128 v[208:211], v227 offset:32768
    ds_read_b64_tr_b16 v[212:213], v244 offset:5632
    ds_read_b64_tr_b16 v[214:215], v244 offset:5760
    s_mov_b64 exec, s[48:49]
    ds_read_b128 v[212:215], v245 offset:352
    s_mov_b64 exec, -1
    s_waitcnt lgkmcnt(8)
    v_mfma_f32_32x32x16_bf16 v[104:119], v[196:199], v[192:195], v[104:119]
    ds_read_b128 v[184:187], v224 offset:49152
    ds_read_b64_tr_b16 v[188:189], v244 offset:6144
    ds_read_b64_tr_b16 v[190:191], v244 offset:6272
    s_mov_b64 exec, s[48:49]
    ds_read_b128 v[188:191], v245 offset:384
    s_mov_b64 exec, -1
    s_waitcnt lgkmcnt(8)
    v_mfma_f32_32x32x16_bf16 v[104:119], v[204:207], v[200:203], v[104:119]
    ds_read_b128 v[192:195], v225 offset:49152
    ds_read_b64_tr_b16 v[196:197], v244 offset:6656
    ds_read_b64_tr_b16 v[198:199], v244 offset:6784
    s_mov_b64 exec, s[48:49]
    ds_read_b128 v[196:199], v245 offset:416
    s_mov_b64 exec, -1
    s_waitcnt lgkmcnt(8)
    v_mfma_f32_32x32x16_bf16 v[104:119], v[212:215], v[208:211], v[104:119]
    ds_read_b128 v[200:203], v226 offset:49152
    ds_read_b64_tr_b16 v[204:205], v244 offset:7168
    ds_read_b64_tr_b16 v[206:207], v244 offset:7296
    s_mov_b64 exec, s[48:49]
    ds_read_b128 v[204:207], v245 offset:448
    s_mov_b64 exec, -1
    s_waitcnt lgkmcnt(8)
    v_mfma_f32_32x32x16_bf16 v[104:119], v[188:191], v[184:187], v[104:119]
    ds_read_b128 v[208:211], v227 offset:49152
    ds_read_b64_tr_b16 v[212:213], v244 offset:7680
    ds_read_b64_tr_b16 v[214:215], v244 offset:7808
    s_mov_b64 exec, s[48:49]
    ds_read_b128 v[212:215], v245 offset:480
    s_mov_b64 exec, -1
    s_waitcnt lgkmcnt(8)
    v_mfma_f32_32x32x16_bf16 v[104:119], v[196:199], v[192:195], v[104:119]
    s_waitcnt lgkmcnt(4)
    v_mfma_f32_32x32x16_bf16 v[104:119], v[204:207], v[200:203], v[104:119]
    s_waitcnt lgkmcnt(0)
    v_mfma_f32_32x32x16_bf16 v[104:119], v[212:215], v[208:211], v[104:119]
    s_waitcnt vmcnt(3)
    s_barrier
    ds_read_b128 v[184:187], v228 offset:0
    ds_read_b64_tr_b16 v[188:189], v244 offset:8192
    ds_read_b64_tr_b16 v[190:191], v244 offset:8320
    s_mov_b64 exec, s[48:49]
    ds_read_b128 v[188:191], v245 offset:512
    s_mov_b64 exec, -1
    ds_read_b128 v[192:195], v229 offset:0
    ds_read_b64_tr_b16 v[196:197], v244 offset:8704
    ds_read_b64_tr_b16 v[198:199], v244 offset:8832
    s_mov_b64 exec, s[48:49]
    ds_read_b128 v[196:199], v245 offset:544
    s_mov_b64 exec, -1
    ds_read_b128 v[200:203], v230 offset:0
    ds_read_b64_tr_b16 v[204:205], v244 offset:9216
    ds_read_b64_tr_b16 v[206:207], v244 offset:9344
    s_mov_b64 exec, s[48:49]
    ds_read_b128 v[204:207], v245 offset:576
    s_mov_b64 exec, -1
    s_waitcnt lgkmcnt(8)
    v_mfma_f32_32x32x16_bf16 v[104:119], v[188:191], v[184:187], v[104:119]
    ds_read_b128 v[208:211], v231 offset:0
    ds_read_b64_tr_b16 v[212:213], v244 offset:9728
    ds_read_b64_tr_b16 v[214:215], v244 offset:9856
    s_mov_b64 exec, s[48:49]
    ds_read_b128 v[212:215], v245 offset:608
    s_mov_b64 exec, -1
    s_waitcnt lgkmcnt(8)
    v_mfma_f32_32x32x16_bf16 v[104:119], v[196:199], v[192:195], v[104:119]
    ds_read_b128 v[184:187], v228 offset:16384
    ds_read_b64_tr_b16 v[188:189], v244 offset:10240
    ds_read_b64_tr_b16 v[190:191], v244 offset:10368
    s_mov_b64 exec, s[48:49]
    ds_read_b128 v[188:191], v245 offset:640
    s_mov_b64 exec, -1
    s_waitcnt lgkmcnt(8)
    v_mfma_f32_32x32x16_bf16 v[104:119], v[204:207], v[200:203], v[104:119]
    ds_read_b128 v[192:195], v229 offset:16384
    ds_read_b64_tr_b16 v[196:197], v244 offset:10752
    ds_read_b64_tr_b16 v[198:199], v244 offset:10880
    s_mov_b64 exec, s[48:49]
    ds_read_b128 v[196:199], v245 offset:672
    s_mov_b64 exec, -1
    s_waitcnt lgkmcnt(8)
    v_mfma_f32_32x32x16_bf16 v[104:119], v[212:215], v[208:211], v[104:119]
    ds_read_b128 v[200:203], v230 offset:16384
    ds_read_b64_tr_b16 v[204:205], v244 offset:11264
    ds_read_b64_tr_b16 v[206:207], v244 offset:11392
    s_mov_b64 exec, s[48:49]
    ds_read_b128 v[204:207], v245 offset:704
    s_mov_b64 exec, -1
    s_waitcnt lgkmcnt(8)
    v_mfma_f32_32x32x16_bf16 v[104:119], v[188:191], v[184:187], v[104:119]
    ds_read_b128 v[208:211], v231 offset:16384
    ds_read_b64_tr_b16 v[212:213], v244 offset:11776
    ds_read_b64_tr_b16 v[214:215], v244 offset:11904
    s_mov_b64 exec, s[48:49]
    ds_read_b128 v[212:215], v245 offset:736
    s_mov_b64 exec, -1
    s_waitcnt lgkmcnt(8)
    v_mfma_f32_32x32x16_bf16 v[104:119], v[196:199], v[192:195], v[104:119]
    s_waitcnt lgkmcnt(4)
    v_mfma_f32_32x32x16_bf16 v[104:119], v[204:207], v[200:203], v[104:119]
    s_waitcnt lgkmcnt(0)
    v_mfma_f32_32x32x16_bf16 v[104:119], v[212:215], v[208:211], v[104:119]
    s_waitcnt vmcnt(1)
    s_barrier
    ds_read_b128 v[184:187], v228 offset:32768
    ds_read_b64_tr_b16 v[188:189], v244 offset:12288
    ds_read_b64_tr_b16 v[190:191], v244 offset:12416
    s_mov_b64 exec, s[48:49]
    ds_read_b128 v[188:191], v245 offset:768
    s_mov_b64 exec, -1
    ds_read_b128 v[192:195], v229 offset:32768
    ds_read_b64_tr_b16 v[196:197], v244 offset:12800
    ds_read_b64_tr_b16 v[198:199], v244 offset:12928
    s_mov_b64 exec, s[48:49]
    ds_read_b128 v[196:199], v245 offset:800
    s_mov_b64 exec, -1
    ds_read_b128 v[200:203], v230 offset:32768
    ds_read_b64_tr_b16 v[204:205], v244 offset:13312
    ds_read_b64_tr_b16 v[206:207], v244 offset:13440
    s_mov_b64 exec, s[48:49]
    ds_read_b128 v[204:207], v245 offset:832
    s_mov_b64 exec, -1
    s_waitcnt lgkmcnt(8)
    v_mfma_f32_32x32x16_bf16 v[104:119], v[188:191], v[184:187], v[104:119]
    ds_read_b128 v[208:211], v231 offset:32768
    ds_read_b64_tr_b16 v[212:213], v244 offset:13824
    ds_read_b64_tr_b16 v[214:215], v244 offset:13952
    s_mov_b64 exec, s[48:49]
    ds_read_b128 v[212:215], v245 offset:864
    s_mov_b64 exec, -1
    s_waitcnt lgkmcnt(8)
    v_mfma_f32_32x32x16_bf16 v[104:119], v[196:199], v[192:195], v[104:119]
    ds_read_b128 v[184:187], v228 offset:49152
    ds_read_b64_tr_b16 v[188:189], v244 offset:14336
    ds_read_b64_tr_b16 v[190:191], v244 offset:14464
    s_mov_b64 exec, s[48:49]
    ds_read_b128 v[188:191], v245 offset:896
    s_mov_b64 exec, -1
    s_waitcnt lgkmcnt(8)
    v_mfma_f32_32x32x16_bf16 v[104:119], v[204:207], v[200:203], v[104:119]
    ds_read_b128 v[192:195], v229 offset:49152
    ds_read_b64_tr_b16 v[196:197], v244 offset:14848
    ds_read_b64_tr_b16 v[198:199], v244 offset:14976
    s_mov_b64 exec, s[48:49]
    ds_read_b128 v[196:199], v245 offset:928
    s_mov_b64 exec, -1
    s_waitcnt lgkmcnt(8)
    v_mfma_f32_32x32x16_bf16 v[104:119], v[212:215], v[208:211], v[104:119]
    ds_read_b128 v[200:203], v230 offset:49152
    ds_read_b64_tr_b16 v[204:205], v244 offset:15360
    ds_read_b64_tr_b16 v[206:207], v244 offset:15488
    s_mov_b64 exec, s[48:49]
    ds_read_b128 v[204:207], v245 offset:960
    s_mov_b64 exec, -1
    s_waitcnt lgkmcnt(8)
    v_mfma_f32_32x32x16_bf16 v[104:119], v[188:191], v[184:187], v[104:119]
    ds_read_b128 v[208:211], v231 offset:49152
    ds_read_b64_tr_b16 v[212:213], v244 offset:15872
    ds_read_b64_tr_b16 v[214:215], v244 offset:16000
    s_mov_b64 exec, s[48:49]
    ds_read_b128 v[212:215], v245 offset:992
    s_mov_b64 exec, -1
    s_waitcnt lgkmcnt(8)
    v_mfma_f32_32x32x16_bf16 v[104:119], v[196:199], v[192:195], v[104:119]
    s_waitcnt lgkmcnt(4)
    v_mfma_f32_32x32x16_bf16 v[104:119], v[204:207], v[200:203], v[104:119]
    s_waitcnt lgkmcnt(0)
    v_mfma_f32_32x32x16_bf16 v[104:119], v[212:215], v[208:211], v[104:119]
    s_lshl_b32 s68, s53, 2
    s_add_u32 s68, s68, s77
    s_nop 12
    s_mov_b32 s70, 0x3eb8aa3b
    v_mul_f32 v104, s70, v104
    v_mul_f32 v105, s70, v105
    v_mul_f32 v106, s70, v106
    v_mul_f32 v107, s70, v107
    v_mul_f32 v108, s70, v108
    v_mul_f32 v109, s70, v109
    v_mul_f32 v110, s70, v110
    v_mul_f32 v111, s70, v111
    v_mul_f32 v112, 0xbfb8aa3b, v112
    v_exp_f32 v112, v112
    v_cvt_pk_bf16_f32 v184, v104, v105
    v_cvt_pk_bf16_f32 v185, v106, v107
    v_cvt_pk_bf16_f32 v186, v108, v109
    v_cvt_pk_bf16_f32 v187, v110, v111
    v_add_f32 v112, 1.0, v112
    v_rcp_f32 v112, v112
    s_add_u32 s69, s68, 63
    s_and_b32 s69, s69, 63
    s_lshl_b32 s69, s69, 11
    buffer_store_dwordx4 v[184:187], v1, s[64:67], s69 offen sc1
    s_lshl_b32 s69, s68, 7
    s_add_u32 s69, s69, 0x20000
    s_mov_b32 exec_hi, 0
    buffer_store_dword v112, v15, s[20:23], s69 offen sc1
    s_mov_b64 exec, -1
    s_branch L_lJ
L_lV:
    s_waitcnt vmcnt(9)
    s_barrier
    ds_read_b128 v[184:187], v224 offset:0
    ds_read_b64_tr_b16 v[188:189], v244 offset:0
    ds_read_b64_tr_b16 v[190:191], v244 offset:128
    ds_read_b128 v[192:195], v225 offset:0
    ds_read_b64_tr_b16 v[196:197], v244 offset:512
    ds_read_b64_tr_b16 v[198:199], v244 offset:640
    ds_read_b128 v[200:203], v226 offset:0
    ds_read_b64_tr_b16 v[204:205], v244 offset:1024
    ds_read_b64_tr_b16 v[206:207], v244 offset:1152
    s_waitcnt lgkmcnt(6)
    v_mfma_f32_32x32x16_bf16 v[104:119], v[184:187], v[188:191], 0
    ds_read_b128 v[208:211], v227 offset:0
    ds_read_b64_tr_b16 v[212:213], v244 offset:1536
    ds_read_b64_tr_b16 v[214:215], v244 offset:1664
    s_waitcnt lgkmcnt(6)
    v_mfma_f32_32x32x16_bf16 v[104:119], v[192:195], v[196:199], v[104:119]
    ds_read_b128 v[184:187], v224 offset:16384
    ds_read_b64_tr_b16 v[188:189], v244 offset:2048
    ds_read_b64_tr_b16 v[190:191], v244 offset:2176
    s_waitcnt lgkmcnt(6)
    v_mfma_f32_32x32x16_bf16 v[104:119], v[200:203], v[204:207], v[104:119]
    ds_read_b128 v[192:195], v225 offset:16384
    ds_read_b64_tr_b16 v[196:197], v244 offset:2560
    ds_read_b64_tr_b16 v[198:199], v244 offset:2688
    s_waitcnt lgkmcnt(6)
    v_mfma_f32_32x32x16_bf16 v[104:119], v[208:211], v[212:215], v[104:119]
    ds_read_b128 v[200:203], v226 offset:16384
    ds_read_b64_tr_b16 v[204:205], v244 offset:3072
    ds_read_b64_tr_b16 v[206:207], v244 offset:3200
    s_waitcnt lgkmcnt(6)
    v_mfma_f32_32x32x16_bf16 v[104:119], v[184:187], v[188:191], v[104:119]
    ds_read_b128 v[208:211], v227 offset:16384
    ds_read_b64_tr_b16 v[212:213], v244 offset:3584
    ds_read_b64_tr_b16 v[214:215], v244 offset:3712
    s_waitcnt lgkmcnt(6)
    v_mfma_f32_32x32x16_bf16 v[104:119], v[192:195], v[196:199], v[104:119]
    s_waitcnt lgkmcnt(3)
    v_mfma_f32_32x32x16_bf16 v[104:119], v[200:203], v[204:207], v[104:119]
    s_waitcnt lgkmcnt(0)
    v_mfma_f32_32x32x16_bf16 v[104:119], v[208:211], v[212:215], v[104:119]
    s_waitcnt vmcnt(7)
    s_barrier
    ds_read_b128 v[184:187], v224 offset:32768
    ds_read_b64_tr_b16 v[188:189], v244 offset:4096
    ds_read_b64_tr_b16 v[190:191], v244 offset:4224
    ds_read_b128 v[192:195], v225 offset:32768
    ds_read_b64_tr_b16 v[196:197], v244 offset:4608
    ds_read_b64_tr_b16 v[198:199], v244 offset:4736
    ds_read_b128 v[200:203], v226 offset:32768
    ds_read_b64_tr_b16 v[204:205], v244 offset:5120
    ds_read_b64_tr_b16 v[206:207], v244 offset:5248
    s_waitcnt lgkmcnt(6)
    v_mfma_f32_32x32x16_bf16 v[104:119], v[184:187], v[188:191], v[104:119]
    ds_read_b128 v[208:211], v227 offset:32768
    ds_read_b64_tr_b16 v[212:213], v244 offset:5632
    ds_read_b64_tr_b16 v[214:215], v244 offset:5760
    s_waitcnt lgkmcnt(6)
    v_mfma_f32_32x32x16_bf16 v[104:119], v[192:195], v[196:199], v[104:119]
    ds_read_b128 v[184:187], v224 offset:49152
    ds_read_b64_tr_b16 v[188:189], v244 offset:6144
    ds_read_b64_tr_b16 v[190:191], v244 offset:6272
    s_waitcnt lgkmcnt(6)
    v_mfma_f32_32x32x16_bf16 v[104:119], v[200:203], v[204:207], v[104:119]
    ds_read_b128 v[192:195], v225 offset:49152
    ds_read_b64_tr_b16 v[196:197], v244 offset:6656
    ds_read_b64_tr_b16 v[198:199], v244 offset:6784
    s_waitcnt lgkmcnt(6)
    v_mfma_f32_32x32x16_bf16 v[104:119], v[208:211], v[212:215], v[104:119]
    ds_read_b128 v[200:203], v226 offset:49152
    ds_read_b64_tr_b16 v[204:205], v244 offset:7168
    ds_read_b64_tr_b16 v[206:207], v244 offset:7296
    s_waitcnt lgkmcnt(6)
    v_mfma_f32_32x32x16_bf16 v[104:119], v[184:187], v[188:191], v[104:119]
    ds_read_b128 v[208:211], v227 offset:49152
    ds_read_b64_tr_b16 v[212:213], v244 offset:7680
    ds_read_b64_tr_b16 v[214:215], v244 offset:7808
    s_waitcnt lgkmcnt(6)
    v_mfma_f32_32x32x16_bf16 v[104:119], v[192:195], v[196:199], v[104:119]
    s_waitcnt lgkmcnt(3)
    v_mfma_f32_32x32x16_bf16 v[104:119], v[200:203], v[204:207], v[104:119]
    s_waitcnt lgkmcnt(0)
    v_mfma_f32_32x32x16_bf16 v[104:119], v[208:211], v[212:215], v[104:119]
    s_waitcnt vmcnt(3)
    s_barrier
    ds_read_b128 v[184:187], v228 offset:0
    ds_read_b64_tr_b16 v[188:189], v244 offset:8192
    ds_read_b64_tr_b16 v[190:191], v244 offset:8320
    ds_read_b128 v[192:195], v229 offset:0
    ds_read_b64_tr_b16 v[196:197], v244 offset:8704
    ds_read_b64_tr_b16 v[198:199], v244 offset:8832
    ds_read_b128 v[200:203], v230 offset:0
    ds_read_b64_tr_b16 v[204:205], v244 offset:9216
    ds_read_b64_tr_b16 v[206:207], v244 offset:9344
    s_waitcnt lgkmcnt(6)
    v_mfma_f32_32x32x16_bf16 v[104:119], v[184:187], v[188:191], v[104:119]
    ds_read_b128 v[208:211], v231 offset:0
    ds_read_b64_tr_b16 v[212:213], v244 offset:9728
    ds_read_b64_tr_b16 v[214:215], v244 offset:9856
    s_waitcnt lgkmcnt(6)
    v_mfma_f32_32x32x16_bf16 v[104:119], v[192:195], v[196:199], v[104:119]
    ds_read_b128 v[184:187], v228 offset:16384
    ds_read_b64_tr_b16 v[188:189], v244 offset:10240
    ds_read_b64_tr_b16 v[190:191], v244 offset:10368
    s_waitcnt lgkmcnt(6)
    v_mfma_f32_32x32x16_bf16 v[104:119], v[200:203], v[204:207], v[104:119]
    ds_read_b128 v[192:195], v229 offset:16384
    ds_read_b64_tr_b16 v[196:197], v244 offset:10752
    ds_read_b64_tr_b16 v[198:199], v244 offset:10880
    s_waitcnt lgkmcnt(6)
    v_mfma_f32_32x32x16_bf16 v[104:119], v[208:211], v[212:215], v[104:119]
    ds_read_b128 v[200:203], v230 offset:16384
    ds_read_b64_tr_b16 v[204:205], v244 offset:11264
    ds_read_b64_tr_b16 v[206:207], v244 offset:11392
    s_waitcnt lgkmcnt(6)
    v_mfma_f32_32x32x16_bf16 v[104:119], v[184:187], v[188:191], v[104:119]
    ds_read_b128 v[208:211], v231 offset:16384
    ds_read_b64_tr_b16 v[212:213], v244 offset:11776
    ds_read_b64_tr_b16 v[214:215], v244 offset:11904
    s_waitcnt lgkmcnt(6)
    v_mfma_f32_32x32x16_bf16 v[104:119], v[192:195], v[196:199], v[104:119]
    s_waitcnt lgkmcnt(3)
    v_mfma_f32_32x32x16_bf16 v[104:119], v[200:203], v[204:207], v[104:119]
    s_waitcnt lgkmcnt(0)
    v_mfma_f32_32x32x16_bf16 v[104:119], v[208:211], v[212:215], v[104:119]
    s_waitcnt vmcnt(1)
    s_barrier
    ds_read_b128 v[184:187], v228 offset:32768
    ds_read_b64_tr_b16 v[188:189], v244 offset:12288
    ds_read_b64_tr_b16 v[190:191], v244 offset:12416
    ds_read_b128 v[192:195], v229 offset:32768
    ds_read_b64_tr_b16 v[196:197], v244 offset:12800
    ds_read_b64_tr_b16 v[198:199], v244 offset:12928
    ds_read_b128 v[200:203], v230 offset:32768
    ds_read_b64_tr_b16 v[204:205], v244 offset:13312
    ds_read_b64_tr_b16 v[206:207], v244 offset:13440
    s_waitcnt lgkmcnt(6)
    v_mfma_f32_32x32x16_bf16 v[104:119], v[184:187], v[188:191], v[104:119]
    ds_read_b128 v[208:211], v231 offset:32768
    ds_read_b64_tr_b16 v[212:213], v244 offset:13824
    ds_read_b64_tr_b16 v[214:215], v244 offset:13952
    s_waitcnt lgkmcnt(6)
    v_mfma_f32_32x32x16_bf16 v[104:119], v[192:195], v[196:199], v[104:119]
    ds_read_b128 v[184:187], v228 offset:49152
    ds_read_b64_tr_b16 v[188:189], v244 offset:14336
    ds_read_b64_tr_b16 v[190:191], v244 offset:14464
    s_waitcnt lgkmcnt(6)
    v_mfma_f32_32x32x16_bf16 v[104:119], v[200:203], v[204:207], v[104:119]
    ds_read_b128 v[192:195], v229 offset:49152
    ds_read_b64_tr_b16 v[196:197], v244 offset:14848
    ds_read_b64_tr_b16 v[198:199], v244 offset:14976
    s_waitcnt lgkmcnt(6)
    v_mfma_f32_32x32x16_bf16 v[104:119], v[208:211], v[212:215], v[104:119]
    ds_read_b128 v[200:203], v230 offset:49152
    ds_read_b64_tr_b16 v[204:205], v244 offset:15360
    ds_read_b64_tr_b16 v[206:207], v244 offset:15488
    s_waitcnt lgkmcnt(6)
    v_mfma_f32_32x32x16_bf16 v[104:119], v[184:187], v[188:191], v[104:119]
    ds_read_b128 v[208:211], v231 offset:49152
    ds_read_b64_tr_b16 v[212:213], v244 offset:15872
    ds_read_b64_tr_b16 v[214:215], v244 offset:16000
    s_waitcnt lgkmcnt(6)
    v_mfma_f32_32x32x16_bf16 v[104:119], v[192:195], v[196:199], v[104:119]
    s_waitcnt lgkmcnt(3)
    v_mfma_f32_32x32x16_bf16 v[104:119], v[200:203], v[204:207], v[104:119]
    s_waitcnt lgkmcnt(0)
    v_mfma_f32_32x32x16_bf16 v[104:119], v[208:211], v[212:215], v[104:119]
    s_lshl_b32 s68, s53, 2
    s_add_u32 s68, s68, s77
    s_nop 12
    v_cvt_pk_bf16_f32 v184, v104, v105
    v_cvt_pk_bf16_f32 v185, v106, v107
    v_cvt_pk_bf16_f32 v186, v108, v109
    v_cvt_pk_bf16_f32 v187, v110, v111
    v_cvt_pk_bf16_f32 v188, v112, v113
    v_cvt_pk_bf16_f32 v189, v114, v115
    v_cvt_pk_bf16_f32 v190, v116, v117
    v_cvt_pk_bf16_f32 v191, v118, v119
    v_bfe_u32 v2, v0, 4, 1
    v_add_u32 v2, s68, v2
    v_and_b32 v2, 63, v2
    v_lshl_add_u32 v2, v2, 11, v1
    v_cndmask_b32 v184, v188, v184, s[60:61]
    v_cndmask_b32 v185, v189, v185, s[60:61]
    v_cndmask_b32 v186, v190, v186, s[60:61]
    v_cndmask_b32 v187, v191, v187, s[60:61]
    buffer_store_dwordx4 v[184:187], v2, s[64:67], 0 offen offset:1024 sc1
    s_branch L_lJ
L_lB:
    s_cmp_lg_u32 s54, 14
    s_cbranch_scc1 L_nozf
    s_cmp_lg_u32 s50, 4
    s_cbranch_scc1 L_nozf
    v_lshlrev_b32 v2, 7, v0
    s_lshl_b32 s68, s53, 11
    s_add_u32 s68, s68, 0x30000
    s_mov_b64 exec, 0xffff
    buffer_store_dword v12, v2, s[20:23], s68 offen sc1
    s_mov_b64 exec, -1
L_nozf:
    s_waitcnt vmcnt(9)
    s_barrier
    s_waitcnt vmcnt(7)
    s_barrier
    s_waitcnt vmcnt(3)
    s_barrier
    s_waitcnt vmcnt(1)
    s_barrier
L_lJ:
    v_lshrrev_b32 v3, 2, v0
    v_lshlrev_b32 v3, 10, v3
    v_lshrrev_b32 v4, 5, v0
    v_lshlrev_b32 v4, 1, v4
    v_xor_b32 v4, v4, v0
    v_and_b32 v4, 3, v4
    v_lshl_add_u32 v3, v4, 4, v3
    s_lshl_b32 s68, s50, 14
    s_lshl_b32 s69, s81, 6
    s_add_u32 s68, s68, s69
    v_add_u32 v251, s68, v3
    s_xor_b32 s58, s58, 0x2000
    s_xor_b32 s79, s79, 0x10000
    s_waitcnt vmcnt(0) lgkmcnt(0)
    s_barrier
    s_cmp_lg_u32 s50, 0
    s_cbranch_scc1 L_noat
    s_mov_b64 exec, 1
    buffer_atomic_add v11, off, s[36:39], 0 sc1
    s_mov_b64 exec, -1
L_noat:
    s_add_u32 m0, s58, 0x0
    s_nop 0
    buffer_load_dwordx4 v249, s[4:7], s79 offen offset:0 lds
    s_add_u32 m0, s58, 0x3f80
    s_nop 0
    buffer_load_dwordx4 v249, s[4:7], s79 offen offset:128 lds
    s_add_u32 m0, s58, 0x7f00
    s_nop 0
    buffer_load_dwordx4 v249, s[4:7], s79 offen offset:256 lds
    s_add_u32 m0, s58, 0xbe80
    s_nop 0
    buffer_load_dwordx4 v249, s[4:7], s79 offen offset:384 lds
    s_add_u32 m0, s58, 0xfe00
    s_nop 0
    buffer_load_dwordx4 v249, s[4:7], s79 offen offset:512 lds
    s_add_u32 m0, s58, 0x13d80
    s_nop 0
    buffer_load_dwordx4 v249, s[4:7], s79 offen offset:640 lds
    s_add_u32 m0, s58, 0x17d00
    s_nop 0
    buffer_load_dwordx4 v249, s[4:7], s79 offen offset:768 lds
    s_add_u32 m0, s58, 0x1bc80
    s_nop 0
    buffer_load_dwordx4 v249, s[4:7], s79 offen offset:896 lds
    s_add_u32 m0, s57, 0x20000
    s_mov_b32 s68, 0x0
    buffer_load_dwordx4 v251, s[16:19], s68 offen lds
    s_add_u32 m0, s57, 0x22000
    s_mov_b32 s68, 0x20000
    buffer_load_dwordx4 v251, s[16:19], s68 offen lds
    s_add_u32 m0, s57, 0x24000
    s_mov_b32 s68, 0x40000
    buffer_load_dwordx4 v251, s[16:19], s68 offen lds
    s_add_u32 m0, s57, 0x26000
    s_mov_b32 s68, 0x60000
    buffer_load_dwordx4 v251, s[16:19], s68 offen lds
    s_mov_b32 s68, 0x110000
    s_mov_b32 s69, 0x110000
    v_mov_b32 v3, 0x3f803f80
    v_cndmask_b32 v24, 0, v3, s[68:69]
    v_mov_b32 v25, v24
    v_mov_b32 v26, v24
    v_mov_b32 v27, v24
    v_mov_b32 v40, v24
    v_mov_b32 v41, v24
    v_mov_b32 v42, v24
    v_mov_b32 v43, v24
    v_mov_b32 v44, v24
    v_mov_b32 v45, v24
    v_mov_b32 v46, v24
    v_mov_b32 v47, v24
    v_mov_b32 v48, v24
    v_mov_b32 v49, v24
    v_mov_b32 v50, v24
    v_mov_b32 v51, v24
    v_mov_b32 v52, v24
    v_mov_b32 v53, v24
    v_mov_b32 v54, v24
    v_mov_b32 v55, v24
    s_mov_b32 s26, 0x1c0000
    s_mov_b32 s27, 0x20000
    s_mov_b32 s30, 0x80000
    s_mov_b32 s31, 0x20000
    s_mov_b32 s34, 0x200000
    s_mov_b32 s35, 0x20000
    s_lshl_b32 s68, s53, 2
    s_add_u32 s68, s68, s52
    s_mul_i32 s69, s68, 112
    s_lshl_b32 s70, s54, 3
    s_add_u32 s69, s69, s70
    s_lshl_b32 s70, s51, 2
    s_add_u32 s69, s69, s70
    s_and_b32 s70, s52, 1
    s_lshl_b32 s70, s70, 1
    s_add_u32 s69, s69, s70
    s_lshl_b32 s69, s69, 10
    s_add_u32 s80, s69, 0x400000
    s_mul_i32 s70, s70, 114688
    s_sub_u32 s70, 114688, s70
    s_add_u32 s3, s80, s70
    v_bfe_u32 v2, v0, 2, 2
    v_lshrrev_b32 v3, 5, v0
    v_lshl_add_u32 v2, v3, 2, v2
    v_lshlrev_b32 v2, 6, v2
    v_bfe_u32 v3, v0, 4, 1
    v_lshl_add_u32 v2, v3, 5, v2
    v_and_b32 v3, 3, v0
    v_lshl_add_u32 v2, v3, 3, v2
    s_lshr_b32 s68, s50, 1
    s_lshl_b32 s68, s68, 11
    v_add_u32 v9, s68, v2
    v_add_u32 v8, 0x20000, v1
    v_add_u32 v29, 0x24000, v1
    v_bfe_u32 v2, v0, 2, 3
    v_lshlrev_b32 v2, 10, v2
    v_lshrrev_b32 v3, 5, v0
    v_lshl_add_u32 v2, v3, 6, v2
    v_and_b32 v3, 3, v0
    v_lshl_add_u32 v2, v3, 4, v2
    s_lshl_b32 s69, s56, 7
    v_add_u32 v10, s69, v2
    v_min_u32 v2, 13, v0
    v_lshlrev_b32 v2, 7, v2
    s_lshr_b32 s68, s55, 1
    s_lshl_b32 s68, s68, 11
    s_add_u32 s68, s68, 0x30000
    v_add_u32 v13, s68, v2
    s_lshl_b32 s68, s55, 1
    s_and_b32 s69, s50, 1
    s_add_u32 s68, s68, s69
    s_lshl_b32 s69, s68, 15
    s_lshr_b32 s76, s50, 1
    s_and_b32 s76, s50, 2
    s_add_u32 s76, s76, s51
    s_lshl_b32 s70, s76, 13
    s_add_u32 s69, s69, s70
    s_add_u32 s79, s69, 0x100000
    v_and_b32 v2, 31, v0
    v_lshrrev_b32 v3, 5, v0
    v_and_b32 v4, 7, v0
    v_xor_b32 v3, v3, v4
    v_lshlrev_b32 v3, 4, v3
    v_lshl_add_u32 v3, v2, 8, v3
    s_and_b32 s69, s50, 1
    s_lshl_b32 s69, s69, 15
    s_lshr_b32 s70, s50, 1
    s_lshl_b32 s71, s70, 13
    s_add_u32 s59, s71, s69
    s_add_u32 s71, s59, 0x18000
    v_add_u32 v30, s71, v3
    v_lshrrev_b32 v2, 3, v0
    v_lshlrev_b32 v3, 1, v4
    v_xor_b32 v3, v3, v2
    v_lshlrev_b32 v3, 4, v3
    v_lshl_add_u32 v3, v2, 8, v3
    s_lshl_b32 s71, s70, 11
    s_add_u32 s71, s71, s69
    s_add_u32 s71, s71, 0x18000
    v_add_u32 v31, s71, v3
    v_lshlrev_b32 v4, 4, v4
    v_lshl_add_u32 v12, v2, 10, v4
    s_lshl_b32 s70, s55, 16
    s_add_u32 s59, s59, s70
    s_lshl_b32 s70, s56, 7
    s_add_u32 s59, s59, s70
    v_mov_b32 v28, 0xdddd
    v_lshrrev_b32 v2, 4, v0
    v_lshl_add_u32 v254, v2, 8, v1
    v_mov_b32 v56, 0
    v_mov_b32 v57, 0
    v_mov_b32 v58, 0
    v_mov_b32 v59, 0
    v_mov_b32 v60, 0
    v_mov_b32 v61, 0
    v_mov_b32 v62, 0
    v_mov_b32 v63, 0
    v_mov_b32 v64, 0
    v_mov_b32 v65, 0
    v_mov_b32 v66, 0
    v_mov_b32 v67, 0
    v_mov_b32 v68, 0
    v_mov_b32 v69, 0
    v_mov_b32 v70, 0
    v_mov_b32 v71, 0
    v_mov_b32 v72, 0
    v_mov_b32 v73, 0
    v_mov_b32 v74, 0
    v_mov_b32 v75, 0
    v_mov_b32 v76, 0
    v_mov_b32 v77, 0
    v_mov_b32 v78, 0
    v_mov_b32 v79, 0
    v_mov_b32 v80, 0
    v_mov_b32 v81, 0
    v_mov_b32 v82, 0
    v_mov_b32 v83, 0
    v_mov_b32 v84, 0
    v_mov_b32 v85, 0
    v_mov_b32 v86, 0
    v_mov_b32 v87, 0
    v_mov_b32 v88, 0
    v_mov_b32 v89, 0
    v_mov_b32 v90, 0
    v_mov_b32 v91, 0
    v_mov_b32 v92, 0
    v_mov_b32 v93, 0
    v_mov_b32 v94, 0
    v_mov_b32 v95, 0
    v_mov_b32 v96, 0
    v_mov_b32 v97, 0
    v_mov_b32 v98, 0
    v_mov_b32 v99, 0
    v_mov_b32 v100, 0
    v_mov_b32 v101, 0
    v_mov_b32 v102, 0
    v_mov_b32 v103, 0
    v_mov_b32 v252, 0xc0135761
    v_mov_b32 v253, 0xbdd2d3e8
    s_lshl_b32 s68, s53, 1
    s_add_u32 s68, s68, s54
    s_sub_u32 s68, s68, 14
    s_lshl_b32 s68, s68, 3
    s_add_u32 s68, s68, s50
    v_lshlrev_b32 v2, 15, v0
    s_lshl_b32 s68, s68, 7
    buffer_load_dword v14, v2, s[28:31], s68 offen
    buffer_load_dword v14, v2, s[24:27], s68 offen
    s_lshl_b32 s68, s52, 12
    v_add_u32 v240, s68, v240
    v_xor_b32 v241, 64, v240
    v_add_u32 v242, 0x10000, v240
    v_add_u32 v243, 0x10000, v241
    v_add_u32 v248, 0x20000, v248
    s_waitcnt vmcnt(2)
    s_barrier
    ds_read_b128 v[184:187], v240 offset:0
    ds_read_b128 v[188:191], v240 offset:2048
    ds_read_b64_tr_b16 v[192:193], v248 offset:0
    ds_read_b64_tr_b16 v[194:195], v248 offset:256
    ds_read_b128 v[196:199], v241 offset:0
    ds_read_b128 v[200:203], v241 offset:2048
    ds_read_b64_tr_b16 v[204:205], v248 offset:2048
    ds_read_b64_tr_b16 v[206:207], v248 offset:2304
    s_waitcnt lgkmcnt(4)
    v_mfma_f32_16x16x32_bf16 v[32:35], v[192:195], v[184:187], 0
    v_mfma_f32_16x16x32_bf16 v[36:39], v[192:195], v[188:191], 0
    ds_read_b128 v[208:211], v240 offset:16384
    ds_read_b128 v[212:215], v240 offset:18432
    ds_read_b64_tr_b16 v[216:217], v248 offset:4096
    ds_read_b64_tr_b16 v[218:219], v248 offset:4352
    s_waitcnt lgkmcnt(4)
    v_mfma_f32_16x16x32_bf16 v[32:35], v[204:207], v[196:199], v[32:35]
    v_mfma_f32_16x16x32_bf16 v[36:39], v[204:207], v[200:203], v[36:39]
    ds_read_b128 v[184:187], v241 offset:16384
    ds_read_b128 v[188:191], v241 offset:18432
    ds_read_b64_tr_b16 v[192:193], v248 offset:6144
    ds_read_b64_tr_b16 v[194:195], v248 offset:6400
    s_waitcnt lgkmcnt(4)
    v_mfma_f32_16x16x32_bf16 v[32:35], v[216:219], v[208:211], v[32:35]
    v_mfma_f32_16x16x32_bf16 v[36:39], v[216:219], v[212:215], v[36:39]
    ds_read_b128 v[196:199], v240 offset:32768
    ds_read_b128 v[200:203], v240 offset:34816
    ds_read_b64_tr_b16 v[204:205], v248 offset:8192
    ds_read_b64_tr_b16 v[206:207], v248 offset:8448
    s_waitcnt lgkmcnt(4)
    v_mfma_f32_16x16x32_bf16 v[32:35], v[192:195], v[184:187], v[32:35]
    v_mfma_f32_16x16x32_bf16 v[36:39], v[192:195], v[188:191], v[36:39]
    ds_read_b128 v[208:211], v241 offset:32768
    ds_read_b128 v[212:215], v241 offset:34816
    ds_read_b64_tr_b16 v[216:217], v248 offset:10240
    ds_read_b64_tr_b16 v[218:219], v248 offset:10496
    s_waitcnt lgkmcnt(4)
    v_mfma_f32_16x16x32_bf16 v[32:35], v[204:207], v[196:199], v[32:35]
    v_mfma_f32_16x16x32_bf16 v[36:39], v[204:207], v[200:203], v[36:39]
    ds_read_b128 v[184:187], v240 offset:49152
    ds_read_b128 v[188:191], v240 offset:51200
    ds_read_b64_tr_b16 v[192:193], v248 offset:12288
    ds_read_b64_tr_b16 v[194:195], v248 offset:12544
    s_waitcnt lgkmcnt(4)
    v_mfma_f32_16x16x32_bf16 v[32:35], v[216:219], v[208:211], v[32:35]
    v_mfma_f32_16x16x32_bf16 v[36:39], v[216:219], v[212:215], v[36:39]
    ds_read_b128 v[196:199], v241 offset:49152
    ds_read_b128 v[200:203], v241 offset:51200
    ds_read_b64_tr_b16 v[204:205], v248 offset:14336
    ds_read_b64_tr_b16 v[206:207], v248 offset:14592
    s_waitcnt lgkmcnt(4)
    v_mfma_f32_16x16x32_bf16 v[32:35], v[192:195], v[184:187], v[32:35]
    v_mfma_f32_16x16x32_bf16 v[36:39], v[192:195], v[188:191], v[36:39]
    ds_read_b128 v[208:211], v242 offset:0
    ds_read_b128 v[212:215], v242 offset:2048
    ds_read_b64_tr_b16 v[216:217], v248 offset:16384
    ds_read_b64_tr_b16 v[218:219], v248 offset:16640
    s_waitcnt lgkmcnt(4)
    v_mfma_f32_16x16x32_bf16 v[32:35], v[204:207], v[196:199], v[32:35]
    v_mfma_f32_16x16x32_bf16 v[36:39], v[204:207], v[200:203], v[36:39]
    ds_read_b128 v[184:187], v243 offset:0
    ds_read_b128 v[188:191], v243 offset:2048
    ds_read_b64_tr_b16 v[192:193], v248 offset:18432
    ds_read_b64_tr_b16 v[194:195], v248 offset:18688
    s_waitcnt lgkmcnt(4)
    v_mfma_f32_16x16x32_bf16 v[32:35], v[216:219], v[208:211], v[32:35]
    v_mfma_f32_16x16x32_bf16 v[36:39], v[216:219], v[212:215], v[36:39]
    ds_read_b128 v[196:199], v242 offset:16384
    ds_read_b128 v[200:203], v242 offset:18432
    ds_read_b64_tr_b16 v[204:205], v248 offset:20480
    ds_read_b64_tr_b16 v[206:207], v248 offset:20736
    s_waitcnt lgkmcnt(4)
    v_mfma_f32_16x16x32_bf16 v[32:35], v[192:195], v[184:187], v[32:35]
    v_mfma_f32_16x16x32_bf16 v[36:39], v[192:195], v[188:191], v[36:39]
    ds_read_b128 v[208:211], v243 offset:16384
    ds_read_b128 v[212:215], v243 offset:18432
    ds_read_b64_tr_b16 v[216:217], v248 offset:22528
    ds_read_b64_tr_b16 v[218:219], v248 offset:22784
    s_waitcnt lgkmcnt(4)
    v_mfma_f32_16x16x32_bf16 v[32:35], v[204:207], v[196:199], v[32:35]
    v_mfma_f32_16x16x32_bf16 v[36:39], v[204:207], v[200:203], v[36:39]
    ds_read_b128 v[184:187], v242 offset:32768
    ds_read_b128 v[188:191], v242 offset:34816
    ds_read_b64_tr_b16 v[192:193], v248 offset:24576
    ds_read_b64_tr_b16 v[194:195], v248 offset:24832
    s_waitcnt lgkmcnt(4)
    v_mfma_f32_16x16x32_bf16 v[32:35], v[216:219], v[208:211], v[32:35]
    v_mfma_f32_16x16x32_bf16 v[36:39], v[216:219], v[212:215], v[36:39]
    ds_read_b128 v[196:199], v243 offset:32768
    ds_read_b128 v[200:203], v243 offset:34816
    ds_read_b64_tr_b16 v[204:205], v248 offset:26624
    ds_read_b64_tr_b16 v[206:207], v248 offset:26880
    s_waitcnt lgkmcnt(4)
    v_mfma_f32_16x16x32_bf16 v[32:35], v[192:195], v[184:187], v[32:35]
    v_mfma_f32_16x16x32_bf16 v[36:39], v[192:195], v[188:191], v[36:39]
    ds_read_b128 v[208:211], v242 offset:49152
    ds_read_b128 v[212:215], v242 offset:51200
    ds_read_b64_tr_b16 v[216:217], v248 offset:28672
    ds_read_b64_tr_b16 v[218:219], v248 offset:28928
    s_waitcnt lgkmcnt(4)
    v_mfma_f32_16x16x32_bf16 v[32:35], v[204:207], v[196:199], v[32:35]
    v_mfma_f32_16x16x32_bf16 v[36:39], v[204:207], v[200:203], v[36:39]
    ds_read_b128 v[184:187], v243 offset:49152
    ds_read_b128 v[188:191], v243 offset:51200
    ds_read_b64_tr_b16 v[192:193], v248 offset:30720
    ds_read_b64_tr_b16 v[194:195], v248 offset:30976
    s_waitcnt lgkmcnt(4)
    v_mfma_f32_16x16x32_bf16 v[32:35], v[216:219], v[208:211], v[32:35]
    v_mfma_f32_16x16x32_bf16 v[36:39], v[216:219], v[212:215], v[36:39]
    s_waitcnt lgkmcnt(0)
    v_mfma_f32_16x16x32_bf16 v[32:35], v[192:195], v[184:187], v[32:35]
    v_mfma_f32_16x16x32_bf16 v[36:39], v[192:195], v[188:191], v[36:39]
    s_cmp_lg_u32 s50, 0
    s_cbranch_scc1 L_kvl_done
    s_mov_b32 s69, 0x4000
L_kvl_re:
    buffer_load_dword v14, off, s[36:39], 0 sc1
    s_waitcnt vmcnt(0)
L_kvl_chk:
    v_readfirstlane_b32 s68, v14
    s_cmp_ge_u32 s68, 32
    s_cbranch_scc1 L_kvl_done
    s_sleep 4
    s_sub_u32 s69, s69, 1
    s_cmp_lg_u32 s69, 0
    s_cbranch_scc1 L_kvl_re
L_kvl_done:
    s_barrier
    s_add_u32 m0, s57, 0x20000
    s_add_u32 s68, s57, 0x0
    buffer_load_dwordx4 v1, s[64:67], s68 offen sc1 lds
    s_add_u32 m0, s57, 0x22000
    s_add_u32 s68, s57, 0x2000
    buffer_load_dwordx4 v1, s[64:67], s68 offen sc1 lds
    s_mov_b32 s68, 0x1f800
    buffer_load_dwordx4 v[20:23], v1, s[64:67], s68 offen sc1
    s_mov_b64 exec, s[60:61]
    buffer_load_dwordx4 v[24:27], v1, s[64:67], 0 offen offset:1280 sc1
    s_mov_b64 exec, -1
    s_lshl_b32 s68, s53, 2
    s_add_u32 s68, s68, s52
    s_lshl_b32 s68, s68, 7
    s_add_u32 s68, s68, 0x20000
    buffer_load_dword v6, v15, s[20:23], s68 offen sc1
    s_lshl_b32 s68, s55, 1
    s_and_b32 s69, s50, 1
    s_add_u32 s68, s68, s69
    s_lshl_b32 s68, s68, 7
    s_add_u32 s68, s68, 0x20000
    buffer_load_dword v7, v15, s[20:23], s68 offen sc1
    s_waitcnt vmcnt(0)
    s_branch L_join
L_fb:
    v_mov_b32 v2, 0xff800000
    s_mov_b32 s68, 0
L_fb1:
    buffer_load_dwordx4 v[168:171], v1, s[64:67], s68 offen sc1
    s_waitcnt vmcnt(0)
    v_mfma_f32_32x32x16_bf16 v[104:119], v[168:171], v[16:19], 0
    s_add_u32 s68, s68, 2048
    s_nop 11
    v_max3_f32 v2, v2, v104, v105
    v_max3_f32 v2, v2, v106, v107
    v_max3_f32 v2, v2, v108, v109
    v_max3_f32 v2, v2, v110, v111
    v_max3_f32 v2, v2, v112, v113
    v_max3_f32 v2, v2, v114, v115
    v_max3_f32 v2, v2, v116, v117
    v_max3_f32 v2, v2, v118, v119
    s_cmp_lt_u32 s68, 0x20000
    s_cbranch_scc1 L_fb1
    v_mov_b32 v3, v2
    s_nop 1
    v_permlane32_swap_b32 v2, v3
    s_nop 1
    v_max_f32 v2, v2, v3
    v_sub_f32 v120, 0, v2
    v_sub_f32 v121, 0, v2
    v_sub_f32 v122, 0, v2
    v_sub_f32 v123, 0, v2
    v_sub_f32 v124, 0, v2
    v_sub_f32 v125, 0, v2
    v_sub_f32 v126, 0, v2
    v_sub_f32 v127, 0, v2
    v_sub_f32 v128, 0, v2
    v_sub_f32 v129, 0, v2
    v_sub_f32 v130, 0, v2
    v_sub_f32 v131, 0, v2
    v_sub_f32 v132, 0, v2
    v_sub_f32 v133, 0, v2
    v_sub_f32 v134, 0, v2
    v_sub_f32 v135, 0, v2
    v_mov_b32 v56, 0
    v_mov_b32 v57, 0
    v_mov_b32 v58, 0
    v_mov_b32 v59, 0
    v_mov_b32 v60, 0
    v_mov_b32 v61, 0
    v_mov_b32 v62, 0
    v_mov_b32 v63, 0
    v_mov_b32 v64, 0
    v_mov_b32 v65, 0
    v_mov_b32 v66, 0
    v_mov_b32 v67, 0
    v_mov_b32 v68, 0
    v_mov_b32 v69, 0
    v_mov_b32 v70, 0
    v_mov_b32 v71, 0
    s_mov_b32 s68, 0
L_fb2:
    s_add_u32 s69, s68, 0x1f800
    s_and_b32 s69, s69, 0x1ffff
    buffer_load_dwordx4 v[168:171], v1, s[64:67], s69 offen sc1
    s_add_u32 s69, s68, 2048
    s_and_b32 s69, s69, 0x1ffff
    s_mov_b64 exec, s[60:61]
    buffer_load_dwordx4 v[40:43], v1, s[64:67], s68 offen offset:1024 sc1
    buffer_load_dwordx4 v[44:47], v1, s[64:67], s69 offen offset:1280 sc1
    s_mov_b64 exec, -1
    s_waitcnt vmcnt(0)
    v_mfma_f32_32x32x16_bf16 v[104:119], v[168:171], v[16:19], v[120:135]
    s_add_u32 s68, s68, 2048
    s_nop 11
    v_exp_f32 v104, v104
    v_exp_f32 v105, v105
    v_exp_f32 v106, v106
    v_exp_f32 v107, v107
    v_exp_f32 v108, v108
    v_exp_f32 v109, v109
    v_exp_f32 v110, v110
    v_exp_f32 v111, v111
    v_exp_f32 v112, v112
    v_exp_f32 v113, v113
    v_exp_f32 v114, v114
    v_exp_f32 v115, v115
    v_exp_f32 v116, v116
    v_exp_f32 v117, v117
    v_exp_f32 v118, v118
    v_exp_f32 v119, v119
    s_nop 2
    v_smfmac_f32_32x32x32_bf16 v[56:71], v[40:43], v[104:111], v28
    v_smfmac_f32_32x32x32_bf16 v[56:71], v[44:47], v[112:119], v28
    s_cmp_lt_u32 s68, 0x20000
    s_cbranch_scc1 L_fb2
    s_nop 11
    v_rcp_f32 v4, v64
    s_cmp_eq_u32 s51, 0
    v_mul_f32 v4, v4, v6
    v_mul_f32 v56, v4, v56
    v_mul_f32 v57, v4, v57
    v_mul_f32 v58, v4, v58
    v_mul_f32 v59, v4, v59
    v_mul_f32 v60, v4, v60
    v_mul_f32 v61, v4, v61
    v_mul_f32 v62, v4, v62
    v_mul_f32 v63, v4, v63
    v_cvt_pk_bf16_f32 v20, v56, v57
    v_cvt_pk_bf16_f32 v21, v58, v59
    v_cvt_pk_bf16_f32 v22, v60, v61
    v_cvt_pk_bf16_f32 v23, v62, v63
    v_min_u32 v20, -2, v20
    v_min_u32 v21, -2, v21
    v_min_u32 v22, -2, v22
    v_min_u32 v23, -2, v23
    s_cbranch_scc1 L_fbretA
    s_branch L_fbret
L_codeend:
.section .rodata,"a"
.p2align 6
.amdhsa_kernel gated_mix__grouped_kv_mqa__geglu_ffn__prompt_kernel
  .amdhsa_next_free_vgpr 256
  .amdhsa_next_free_sgpr 102
  .amdhsa_accum_offset 256
  .amdhsa_group_segment_fixed_size 0
  .amdhsa_kernarg_size 104
  .amdhsa_user_sgpr_count 2
  .amdhsa_user_sgpr_kernarg_segment_ptr 1
  .amdhsa_system_sgpr_workgroup_id_x 1
.end_amdhsa_kernel
```
